```python
import torch

def _softmax(x, axis=-1):
    return torch.softmax(x, dim=axis)
def _gelu(x):
    return torch.nn.functional.gelu(x, approximate="tanh")
def _silu(x):
    return torch.nn.functional.silu(x)
def _sigmoid(x):
    return torch.sigmoid(x)
def _layernorm(x, axis=-1, eps=1e-5):
    m = x.mean(dim=axis, keepdim=True)
    v = x.var(dim=axis, keepdim=True, unbiased=False)
    return (x - m) / torch.sqrt(v + eps)
def _scatter_add(tgt, idx, src, axis=0):
    return tgt.clone().index_add_(axis, idx, src)
def _segment_sum(src, seg, n):
    out = torch.zeros((n,) + src.shape[1:], dtype=src.dtype)
    return out.index_add_(0, seg, src)
def _pad(x, pw):
    flat = tuple(v for pair in reversed(pw) for v in pair)
    return torch.nn.functional.pad(x, flat)

kernel_name = 'standalone__weight_only_int_quip__prompt'

def setup_inputs():

    _w = (lambda a: (lambda t: t.to(torch.bfloat16) if t.is_floating_point() else t)(torch.as_tensor(a)))
    B, S, D, F = 1, 2048, 512, 1376
    G = 128 if 128 > 0 else D
    D = (D // G) * G
    ng = D // G
    bits = 4 if 4 > 0 else 4
    qmax = 1 << bits
    qw = torch.randint(0, qmax, (D, F)).to(torch.int32)
    U, _ = (lambda *_a, **_k: torch.linalg.qr(*[torch.as_tensor(_x).float() for _x in _a], **_k))((lambda *s: torch.randn(*s, dtype=torch.bfloat16) * 0.05)(D, D))
    V, _ = (lambda *_a, **_k: torch.linalg.qr(*[torch.as_tensor(_x).float() for _x in _a], **_k))((lambda *s: torch.randn(*s, dtype=torch.bfloat16) * 0.05)(F, F))
    return {
        "x": _w((lambda *s: torch.randn(*s, dtype=torch.bfloat16) * 0.05)(B, S, D)),
        "qw": _w(qw),
        "scales": _w(torch.abs((lambda *s: torch.randn(*s, dtype=torch.bfloat16) * 0.05)(ng, F)) * 0.02 + 0.005),
        "zeros": _w(torch.full((ng, F), qmax / 2.0, dtype=float)),
        "U": _w(U.to(float)),
        "V": _w(V.to(float)),
    }

def reference(x, qw, scales, zeros, U, V):
    B, S, D = x.shape
    ng, F = scales.shape
    G = D // ng
    s = (lambda x, n, axis: torch.repeat_interleave(x, n, dim=axis))(scales, G, axis=0)
    z = (lambda x, n, axis: torch.repeat_interleave(x, n, dim=axis))(zeros, G, axis=0)
    wq = ((lambda x, dt: x.to(dt))(qw, x.dtype) - z) * s
    xr = torch.einsum("bsd,de->bse", x, U)
    h  = torch.einsum("bse,ef->bsf", xr, wq)
    y  = torch.einsum("bsf,fg->bsg", h, V)
    return y
```

```asm
; @launch grid=(256,1,1) block=(256,1,1) lds=147456
.amdgcn_target "amdgcn-amd-amdhsa--gfx950"
.text
.globl standalone__weight_only_int_quip__prompt_kernel
.p2align 8
.type standalone__weight_only_int_quip__prompt_kernel,@function
standalone__weight_only_int_quip__prompt_kernel:
    s_cmp_ge_u32 s2, 256
    s_cbranch_scc1 K_done
    s_load_dwordx16 s[16:31], s[0:1], 0
    s_load_dwordx2 s[32:33], s[0:1], 64
    v_and_b32 v1, 63, v0
    v_lshrrev_b32 v2, 6, v0
    s_and_b32 s4, s2, 7
    v_readfirstlane_b32 s3, v2
    s_lshr_b32 s5, s2, 3
    v_lshrrev_b32 v28, 3, v1
    v_and_b32 v29, 7, v1
    v_lshrrev_b32 v30, 4, v1
    v_and_b32 v31, 15, v1
    s_and_b32 s34, s4, 3
    s_lshl_b32 s34, s34, 2
    s_and_b32 s35, s5, 3
    s_add_u32 s34, s34, s35
    s_lshr_b32 s35, s4, 2
    s_lshl_b32 s35, s35, 3
    s_lshr_b32 s8, s5, 2
    s_add_u32 s35, s35, s8
    s_lshr_b32 s6, s4, 1
    s_lshl_b32 s6, s6, 4
    s_add_u32 s6, s6, s5
    s_lshr_b32 s7, s6, 2
    s_and_b32 s6, s6, 3
    s_and_b32 s8, s4, 1
    s_lshl_b32 s8, s8, 4
    s_add_u32 s7, s7, s8
    s_mul_i32 s10, s6, 11
    s_add_u32 s10, s10, s3
    s_mov_b32 s96, s10
    s_add_u32 s97, s10, 4
    s_cmp_eq_u32 s6, 3
    s_cselect_b32 s11, 10, 11
    s_add_u32 s12, s10, 8
    s_add_u32 s13, s3, 8
    s_cmp_lt_u32 s13, s11
    s_cselect_b32 s98, s12, 0x100000
    s_mov_b32 s100, s7
    s_lshr_b32 s12, s7, 2
    s_lshl_b32 s12, s12, 7
    s_and_b32 s13, s7, 3
    s_lshl_b32 s13, s13, 2
    s_add_u32 s13, s13, s6
    s_lshl_b32 s13, s13, 2
    s_add_u32 s12, s12, s13
    s_add_u32 s99, s12, 8192
    s_lshl_b32 s12, s7, 4
    v_add_u32 v216, s12, v28
    s_movk_i32 s13, 5504
    v_mul_lo_u32 v216, v216, s13
    v_lshl_add_u32 v216, v29, 4, v216
    v_add_u32 v217, 44032, v216
    s_lshr_b32 s12, s7, 3
    s_mul_i32 s12, s12, 2752
    v_lshl_add_u32 v218, v29, 3, s12
    s_waitcnt lgkmcnt(0)
    s_mov_b32 s92, s30
    s_and_b32 s93, s31, 0xffff
    s_mov_b32 s94, 0x100
    s_mov_b32 s95, 0x20000
    s_add_u32 s48, s32, 0x400000
    s_addc_u32 s49, s33, 0
    s_and_b32 s49, s49, 0xffff
    s_mov_b32 s50, 0x158000
    s_mov_b32 s51, 0x20000
    s_cmp_ge_u32 s5, 30
    s_cbranch_scc1 K_nop1
    s_bitcmp1_b32 s4, 1
    s_cselect_b32 s9, 20, 24
    s_cmp_ge_u32 s5, s9
    s_cbranch_scc1 K_a
    s_lshr_b32 s8, s4, 1
    s_mul_i32 s7, s8, 11
    s_add_u32 s7, s7, 1
    s_lshr_b32 s7, s7, 1
    s_lshr_b32 s8, s5, 2
    s_add_u32 s7, s7, s8
    s_and_b32 s6, s4, 1
    s_lshl_b32 s6, s6, 2
    s_and_b32 s8, s5, 3
    s_add_u32 s6, s6, s8
    s_cmp_ge_u32 s5, 16
    s_cbranch_scc1 Kb_np0a
    s_mov_b32 s8, s18
    s_and_b32 s9, s19, 0xffff
    s_mov_b32 s10, 0x2b0000
    s_mov_b32 s11, 0x20000
    s_lshl_b32 s12, s96, 7
    buffer_load_dwordx4 v[184:187], v216, s[8:11], s12 offen
    buffer_load_dwordx4 v[188:191], v217, s[8:11], s12 offen
    s_lshl_b32 s12, s97, 7
    buffer_load_dwordx4 v[192:195], v216, s[8:11], s12 offen
    buffer_load_dwordx4 v[196:199], v217, s[8:11], s12 offen
    s_lshl_b32 s12, s98, 7
    buffer_load_dwordx4 v[200:203], v216, s[8:11], s12 offen
    buffer_load_dwordx4 v[204:207], v217, s[8:11], s12 offen
    s_mov_b32 s8, s20
    s_and_b32 s9, s21, 0xffff
    s_mov_b32 s10, 0x2b00
    s_mov_b32 s11, 0x20000
    s_lshl_b32 s12, s96, 6
    buffer_load_dwordx2 v[220:221], v218, s[8:11], s12 offen
    s_lshl_b32 s12, s97, 6
    buffer_load_dwordx2 v[224:225], v218, s[8:11], s12 offen
    s_lshl_b32 s12, s98, 6
    buffer_load_dwordx2 v[228:229], v218, s[8:11], s12 offen
    s_mov_b32 s8, s22
    s_and_b32 s9, s23, 0xffff
    s_mov_b32 s10, 0x2b00
    s_mov_b32 s11, 0x20000
    s_lshl_b32 s12, s96, 6
    buffer_load_dwordx2 v[222:223], v218, s[8:11], s12 offen
    s_lshl_b32 s12, s97, 6
    buffer_load_dwordx2 v[226:227], v218, s[8:11], s12 offen
    s_lshl_b32 s12, s98, 6
    buffer_load_dwordx2 v[230:231], v218, s[8:11], s12 offen
Kb_np0a:
    s_or_b32 s8, s2, s3
    s_cmp_lg_u32 s8, 0
    s_cbranch_scc1 K_notag1
    s_memrealtime s[8:9]
    s_waitcnt lgkmcnt(0)
    s_or_b32 s8, s8, 1
    v_mov_b32 v209, s8
    v_mov_b32 v211, 0
    s_mov_b64 exec, 1
    buffer_store_dword v209, v211, s[92:95], 0 offen sc1
    s_mov_b64 exec, -1
K_notag1:
    v_lshrrev_b32 v33, 1, v29
    v_bfe_u32 v34, v1, 4, 1
    v_xor_b32 v33, v33, v34
    v_and_b32 v34, 1, v1
    v_lshl_or_b32 v35, v33, 1, v34
    v_lshlrev_b32 v35, 4, v35
    v_mul_u32_u24 v36, 2752, v28
    s_lshl_b32 s12, s7, 7
    v_add3_u32 v6, v35, v36, s12
    v_xor_b32 v35, 64, v35
    v_add3_u32 v7, v35, v36, s12
    s_mul_i32 s57, s3, 88064
    s_lshl_b32 s59, s3, 15
    s_add_u32 s61, s6, s7
    s_and_b32 s61, s61, 3
    s_mul_i32 s61, s61, 3
    s_lshl_b32 s61, s61, 9
    s_mov_b32 s60, s61
    s_mov_b32 s40, s26
    s_and_b32 s41, s27, 0xffff
    s_mov_b32 s42, 0x39c800
    s_mov_b32 s43, 0x20000
    s_mul_i32 s62, s61, 688
    s_add_u32 s62, s62, s57
    s_add_u32 m0, s59, 0
    s_add_u32 s58, s62, 0
    buffer_load_dwordx4 v6, s[40:43], s58 offen offset:0 lds
    s_add_u32 s58, s62, 20992
    buffer_load_dwordx4 v7, s[40:43], s58 offen offset:1024 lds
    s_add_u32 s58, s62, 41984
    buffer_load_dwordx4 v6, s[40:43], s58 offen offset:2048 lds
    s_add_u32 s58, s62, 62976
    buffer_load_dwordx4 v7, s[40:43], s58 offen offset:3072 lds
    s_add_u32 s61, s61, 512
    s_cmp_eq_u32 s61, 5632
    s_cselect_b32 s61, 0, s61
    s_mul_i32 s62, s61, 688
    s_add_u32 s62, s62, s57
    s_add_u32 m0, s59, 4096
    s_add_u32 s58, s62, 0
    buffer_load_dwordx4 v6, s[40:43], s58 offen offset:0 lds
    s_add_u32 s58, s62, 20992
    buffer_load_dwordx4 v7, s[40:43], s58 offen offset:1024 lds
    s_add_u32 s58, s62, 41984
    buffer_load_dwordx4 v6, s[40:43], s58 offen offset:2048 lds
    s_add_u32 s58, s62, 62976
    buffer_load_dwordx4 v7, s[40:43], s58 offen offset:3072 lds
    s_add_u32 s61, s61, 512
    s_cmp_eq_u32 s61, 5632
    s_cselect_b32 s61, 0, s61
    v_bfe_u32 v33, v1, 2, 2
    v_and_b32 v34, 3, v1
    v_lshl_add_u32 v35, v30, 3, v33
    v_lshlrev_b32 v35, 7, v35
    v_bfe_u32 v36, v1, 3, 1
    v_and_b32 v37, 1, v30
    v_lshl_add_u32 v36, v37, 1, v36
    v_lshl_add_u32 v35, v36, 5, v35
    v_lshl_add_u32 v35, v34, 3, v35
    v_add_u32 v8, s59, v35
    v_xor_b32 v9, 32, v8
    v_xor_b32 v10, 64, v8
    v_xor_b32 v11, 96, v8
    v_lshlrev_b32 v2, 4, v1
    s_add_u32 s20, s32, 0x360000
    s_addc_u32 s21, s33, 0
    s_and_b32 s21, s21, 0xffff
    s_mov_b32 s22, 0x4000
    s_mov_b32 s23, 0x20000
    s_cmp_ge_u32 s5, 16
    s_cbranch_scc1 Kb_np0b
    s_lshl_b32 s13, s3, 12
    s_add_u32 s13, s13, 131072
    v_lshrrev_b32 v248, 5, v1
    v_lshrrev_b32 v249, 1, v29
    v_and_b32 v250, 1, v29
    v_lshlrev_b32 v250, 3, v250
    v_lshl_add_u32 v250, v28, 6, v250
    v_add_u32 v250, s13, v250
    v_add_u32 v251, 0, v248
    v_sub_u32 v251, 0, v251
    v_and_b32 v251, 3, v251
    v_xor_b32 v251, v251, v249
    v_lshl_add_u32 v251, v251, 4, v250
    v_add_u32 v244, 0, v251
    v_add_u32 v251, 2, v248
    v_sub_u32 v251, 0, v251
    v_and_b32 v251, 3, v251
    v_xor_b32 v251, v251, v249
    v_lshl_add_u32 v251, v251, 4, v250
    v_add_u32 v245, 512, v251
    v_lshrrev_b32 v251, 2, v31
    v_sub_u32 v251, 0, v251
    v_and_b32 v251, 3, v251
    v_xor_b32 v251, v251, v30
    v_lshlrev_b32 v251, 4, v251
    v_lshl_add_u32 v251, v31, 6, v251
    v_add_u32 v246, s13, v251
    v_lshlrev_b32 v247, 4, v1
    s_mov_b32 s15, 0x4b800000
    s_waitcnt vmcnt(8)
    v_mov_b32 v211, 0
    buffer_load_dword v209, v211, s[92:95], 0 offen sc1
    v_lshlrev_b32 v252, 16, v220
    v_and_b32 v253, 0xffff0000, v220
    v_lshlrev_b32 v254, 16, v221
    v_and_b32 v255, 0xffff0000, v221
    v_lshlrev_b32 v248, 16, v222
    v_and_b32 v249, 0xffff0000, v222
    v_lshlrev_b32 v250, 16, v223
    v_and_b32 v251, 0xffff0000, v223
    v_mul_f32 v248, -v248, v252
    v_mul_f32 v252, s15, v252
    v_mul_f32 v249, -v249, v253
    v_mul_f32 v253, s15, v253
    v_mul_f32 v250, -v250, v254
    v_mul_f32 v254, s15, v254
    v_mul_f32 v251, -v251, v255
    v_mul_f32 v255, s15, v255
    v_fma_mix_f32 v184, v184, v252, v248 op_sel_hi:[1,0,0]
    v_fma_mix_f32 v185, v185, v253, v249 op_sel_hi:[1,0,0]
    v_fma_mix_f32 v186, v186, v254, v250 op_sel_hi:[1,0,0]
    v_fma_mix_f32 v187, v187, v255, v251 op_sel_hi:[1,0,0]
    v_cvt_pk_bf16_f32 v184, v184, v185
    v_cvt_pk_bf16_f32 v185, v186, v187
    ds_write_b64 v244, v[184:185] offset:0
    v_fma_mix_f32 v188, v188, v252, v248 op_sel_hi:[1,0,0]
    v_fma_mix_f32 v189, v189, v253, v249 op_sel_hi:[1,0,0]
    v_fma_mix_f32 v190, v190, v254, v250 op_sel_hi:[1,0,0]
    v_fma_mix_f32 v191, v191, v255, v251 op_sel_hi:[1,0,0]
    v_cvt_pk_bf16_f32 v188, v188, v189
    v_cvt_pk_bf16_f32 v189, v190, v191
    ds_write_b64 v245, v[188:189] offset:0
    v_lshlrev_b32 v252, 16, v224
    v_and_b32 v253, 0xffff0000, v224
    v_lshlrev_b32 v254, 16, v225
    v_and_b32 v255, 0xffff0000, v225
    v_lshlrev_b32 v248, 16, v226
    v_and_b32 v249, 0xffff0000, v226
    v_lshlrev_b32 v250, 16, v227
    v_and_b32 v251, 0xffff0000, v227
    v_mul_f32 v248, -v248, v252
    v_mul_f32 v252, s15, v252
    v_mul_f32 v249, -v249, v253
    v_mul_f32 v253, s15, v253
    v_mul_f32 v250, -v250, v254
    v_mul_f32 v254, s15, v254
    v_mul_f32 v251, -v251, v255
    v_mul_f32 v255, s15, v255
    v_fma_mix_f32 v192, v192, v252, v248 op_sel_hi:[1,0,0]
    v_fma_mix_f32 v193, v193, v253, v249 op_sel_hi:[1,0,0]
    v_fma_mix_f32 v194, v194, v254, v250 op_sel_hi:[1,0,0]
    v_fma_mix_f32 v195, v195, v255, v251 op_sel_hi:[1,0,0]
    v_cvt_pk_bf16_f32 v192, v192, v193
    v_cvt_pk_bf16_f32 v193, v194, v195
    ds_write_b64 v244, v[192:193] offset:1024
    v_fma_mix_f32 v196, v196, v252, v248 op_sel_hi:[1,0,0]
    v_fma_mix_f32 v197, v197, v253, v249 op_sel_hi:[1,0,0]
    v_fma_mix_f32 v198, v198, v254, v250 op_sel_hi:[1,0,0]
    v_fma_mix_f32 v199, v199, v255, v251 op_sel_hi:[1,0,0]
    v_cvt_pk_bf16_f32 v196, v196, v197
    v_cvt_pk_bf16_f32 v197, v198, v199
    ds_write_b64 v245, v[196:197] offset:1024
    v_lshlrev_b32 v252, 16, v228
    v_and_b32 v253, 0xffff0000, v228
    v_lshlrev_b32 v254, 16, v229
    v_and_b32 v255, 0xffff0000, v229
    v_lshlrev_b32 v248, 16, v230
    v_and_b32 v249, 0xffff0000, v230
    v_lshlrev_b32 v250, 16, v231
    v_and_b32 v251, 0xffff0000, v231
    v_mul_f32 v248, -v248, v252
    v_mul_f32 v252, s15, v252
    v_mul_f32 v249, -v249, v253
    v_mul_f32 v253, s15, v253
    v_mul_f32 v250, -v250, v254
    v_mul_f32 v254, s15, v254
    v_mul_f32 v251, -v251, v255
    v_mul_f32 v255, s15, v255
    v_fma_mix_f32 v200, v200, v252, v248 op_sel_hi:[1,0,0]
    v_fma_mix_f32 v201, v201, v253, v249 op_sel_hi:[1,0,0]
    v_fma_mix_f32 v202, v202, v254, v250 op_sel_hi:[1,0,0]
    v_fma_mix_f32 v203, v203, v255, v251 op_sel_hi:[1,0,0]
    v_cvt_pk_bf16_f32 v200, v200, v201
    v_cvt_pk_bf16_f32 v201, v202, v203
    ds_write_b64 v244, v[200:201] offset:2048
    v_fma_mix_f32 v204, v204, v252, v248 op_sel_hi:[1,0,0]
    v_fma_mix_f32 v205, v205, v253, v249 op_sel_hi:[1,0,0]
    v_fma_mix_f32 v206, v206, v254, v250 op_sel_hi:[1,0,0]
    v_fma_mix_f32 v207, v207, v255, v251 op_sel_hi:[1,0,0]
    v_cvt_pk_bf16_f32 v204, v204, v205
    v_cvt_pk_bf16_f32 v205, v206, v207
    ds_write_b64 v245, v[204:205] offset:2048
    ds_read_b128 v[184:187], v246 offset:0
    ds_read_b128 v[188:191], v246 offset:1024
    ds_read_b128 v[192:195], v246 offset:2048
    s_mul_i32 s12, s100, 43
    s_add_u32 s13, s12, s96
    s_lshl_b32 s13, s13, 10
    s_waitcnt lgkmcnt(2)
    buffer_store_dwordx4 v[184:187], v247, s[48:51], s13 offen sc1
    s_add_u32 s13, s12, s97
    s_lshl_b32 s13, s13, 10
    s_waitcnt lgkmcnt(1)
    buffer_store_dwordx4 v[188:191], v247, s[48:51], s13 offen sc1
    s_add_u32 s13, s12, s98
    s_lshl_b32 s13, s13, 10
    s_waitcnt lgkmcnt(0)
    buffer_store_dwordx4 v[192:195], v247, s[48:51], s13 offen sc1
    s_waitcnt vmcnt(0)
    s_mov_b32 s8, 0
P0B_tl:
    v_readfirstlane_b32 s19, v209
    s_nop 3
    s_cmp_lg_u32 s19, 0
    s_cbranch_scc1 P0B_td
    s_add_u32 s8, s8, 1
    s_cmp_ge_u32 s8, 0x10000
    s_cbranch_scc1 P0B_td
    s_sleep 2
    buffer_load_dword v209, v211, s[92:95], 0 offen sc1
    s_waitcnt vmcnt(0)
    s_branch P0B_tl
P0B_td:
    s_barrier
    s_cmp_lg_u32 s3, 0
    s_cbranch_scc1 P0FB
    v_mov_b32 v248, s99
    v_mov_b32 v249, s19
    s_mov_b64 exec, 1
    buffer_store_dword v249, v248, s[20:23], 0 offen sc1
    s_mov_b64 exec, -1
P0FB:
Kb_np0b:
    s_mul_i32 s62, s61, 688
    s_add_u32 s62, s62, s57
    s_add_u32 m0, s59, 8192
    s_add_u32 s58, s62, 0
    buffer_load_dwordx4 v6, s[40:43], s58 offen offset:0 lds
    s_add_u32 s58, s62, 20992
    buffer_load_dwordx4 v7, s[40:43], s58 offen offset:1024 lds
    s_add_u32 s58, s62, 41984
    buffer_load_dwordx4 v6, s[40:43], s58 offen offset:2048 lds
    s_add_u32 s58, s62, 62976
    buffer_load_dwordx4 v7, s[40:43], s58 offen offset:3072 lds
    s_add_u32 s61, s61, 512
    s_cmp_eq_u32 s61, 5632
    s_cselect_b32 s61, 0, s61
    s_mul_i32 s62, s61, 688
    s_add_u32 s62, s62, s57
    s_add_u32 m0, s59, 12288
    s_add_u32 s58, s62, 0
    buffer_load_dwordx4 v6, s[40:43], s58 offen offset:0 lds
    s_add_u32 s58, s62, 20992
    buffer_load_dwordx4 v7, s[40:43], s58 offen offset:1024 lds
    s_add_u32 s58, s62, 41984
    buffer_load_dwordx4 v6, s[40:43], s58 offen offset:2048 lds
    s_add_u32 s58, s62, 62976
    buffer_load_dwordx4 v7, s[40:43], s58 offen offset:3072 lds
    s_add_u32 s61, s61, 512
    s_cmp_eq_u32 s61, 5632
    s_cselect_b32 s61, 0, s61
    s_mul_i32 s62, s61, 688
    s_add_u32 s62, s62, s57
    s_add_u32 m0, s59, 16384
    s_add_u32 s58, s62, 0
    buffer_load_dwordx4 v6, s[40:43], s58 offen offset:0 lds
    s_add_u32 s58, s62, 20992
    buffer_load_dwordx4 v7, s[40:43], s58 offen offset:1024 lds
    s_add_u32 s58, s62, 41984
    buffer_load_dwordx4 v6, s[40:43], s58 offen offset:2048 lds
    s_add_u32 s58, s62, 62976
    buffer_load_dwordx4 v7, s[40:43], s58 offen offset:3072 lds
    s_add_u32 s61, s61, 512
    s_cmp_eq_u32 s61, 5632
    s_cselect_b32 s61, 0, s61
    s_mul_i32 s62, s61, 688
    s_add_u32 s62, s62, s57
    s_add_u32 m0, s59, 20480
    s_add_u32 s58, s62, 0
    buffer_load_dwordx4 v6, s[40:43], s58 offen offset:0 lds
    s_add_u32 s58, s62, 20992
    buffer_load_dwordx4 v7, s[40:43], s58 offen offset:1024 lds
    s_add_u32 s58, s62, 41984
    buffer_load_dwordx4 v6, s[40:43], s58 offen offset:2048 lds
    s_add_u32 s58, s62, 62976
    buffer_load_dwordx4 v7, s[40:43], s58 offen offset:3072 lds
    s_add_u32 s61, s61, 512
    s_cmp_eq_u32 s61, 5632
    s_cselect_b32 s61, 0, s61
    s_mul_i32 s62, s61, 688
    s_add_u32 s62, s62, s57
    s_add_u32 m0, s59, 24576
    s_add_u32 s58, s62, 0
    buffer_load_dwordx4 v6, s[40:43], s58 offen offset:0 lds
    s_add_u32 s58, s62, 20992
    buffer_load_dwordx4 v7, s[40:43], s58 offen offset:1024 lds
    s_add_u32 s58, s62, 41984
    buffer_load_dwordx4 v6, s[40:43], s58 offen offset:2048 lds
    s_add_u32 s58, s62, 62976
    buffer_load_dwordx4 v7, s[40:43], s58 offen offset:3072 lds
    s_add_u32 s61, s61, 512
    s_cmp_eq_u32 s61, 5632
    s_cselect_b32 s61, 0, s61
    s_mul_i32 s62, s61, 688
    s_add_u32 s62, s62, s57
    s_add_u32 m0, s59, 28672
    s_add_u32 s58, s62, 0
    buffer_load_dwordx4 v6, s[40:43], s58 offen offset:0 lds
    s_add_u32 s58, s62, 20992
    buffer_load_dwordx4 v7, s[40:43], s58 offen offset:1024 lds
    s_add_u32 s58, s62, 41984
    buffer_load_dwordx4 v6, s[40:43], s58 offen offset:2048 lds
    s_add_u32 s58, s62, 62976
    buffer_load_dwordx4 v7, s[40:43], s58 offen offset:3072 lds
    s_add_u32 s61, s61, 512
    s_cmp_eq_u32 s61, 5632
    s_cselect_b32 s61, 0, s61
    s_lshl_b32 s8, s6, 7
    s_add_u32 s8, s8, 8192
    v_and_b32 v12, 15, v1
    v_lshl_add_u32 v12, v12, 2, s8
    v_mov_b32 v211, 0
    buffer_load_dword v209, v211, s[92:95], 0 offen sc1
    buffer_load_dword v13, v12, s[20:23], 0 offen sc1
    s_waitcnt vmcnt(0)
    s_mov_b32 s8, 0
TB_tl:
    v_readfirstlane_b32 s19, v209
    s_nop 3
    s_cmp_lg_u32 s19, 0
    s_cbranch_scc1 TB_td
    s_add_u32 s8, s8, 1
    s_cmp_ge_u32 s8, 0x10000
    s_cbranch_scc1 TB_td
    s_sleep 2
    buffer_load_dword v209, v211, s[92:95], 0 offen sc1
    s_waitcnt vmcnt(0)
    s_branch TB_tl
TB_td:
    s_mov_b32 s8, 0
    s_branch PW_chk
PW_loop:
    buffer_load_dword v13, v12, s[20:23], 0 offen sc1
    s_waitcnt vmcnt(0)
PW_chk:
    v_cmp_ne_u32 vcc, s19, v13
    s_nop 4
    s_cbranch_vccz PW_done
    s_sleep 1
    s_add_u32 s8, s8, 1
    s_cmp_lt_u32 s8, 0x10000
    s_cbranch_scc1 PW_loop
PW_done:
    s_mul_i32 s56, s6, 172
    s_add_u32 s56, s56, s3
    s_lshl_b32 s56, s56, 10
    s_cmp_eq_u32 s3, 3
    s_cselect_b32 s63, 0x7f000000, 0
    s_lshl_b32 s62, s60, 3
    s_add_u32 s62, s62, s56
    s_cmp_eq_u32 s60, 5120
    s_cselect_b32 s8, s63, 0
    s_add_u32 s62, s62, s8
    s_add_u32 s9, s62, 0
    buffer_load_dwordx4 v[64:67], v2, s[48:51], s9 offen
    s_add_u32 s9, s62, 44032
    buffer_load_dwordx4 v[68:71], v2, s[48:51], s9 offen
    s_add_u32 s9, s62, 88064
    buffer_load_dwordx4 v[72:75], v2, s[48:51], s9 offen
    s_add_u32 s9, s62, 132096
    buffer_load_dwordx4 v[76:79], v2, s[48:51], s9 offen
    s_add_u32 s60, s60, 512
    s_cmp_eq_u32 s60, 5632
    s_cselect_b32 s60, 0, s60
    s_lshl_b32 s62, s60, 3
    s_add_u32 s62, s62, s56
    s_cmp_eq_u32 s60, 5120
    s_cselect_b32 s8, s63, 0
    s_add_u32 s62, s62, s8
    s_add_u32 s9, s62, 0
    buffer_load_dwordx4 v[80:83], v2, s[48:51], s9 offen
    s_add_u32 s9, s62, 44032
    buffer_load_dwordx4 v[84:87], v2, s[48:51], s9 offen
    s_add_u32 s9, s62, 88064
    buffer_load_dwordx4 v[88:91], v2, s[48:51], s9 offen
    s_add_u32 s9, s62, 132096
    buffer_load_dwordx4 v[92:95], v2, s[48:51], s9 offen
    s_add_u32 s60, s60, 512
    s_cmp_eq_u32 s60, 5632
    s_cselect_b32 s60, 0, s60
    s_lshl_b32 s62, s60, 3
    s_add_u32 s62, s62, s56
    s_cmp_eq_u32 s60, 5120
    s_cselect_b32 s8, s63, 0
    s_add_u32 s62, s62, s8
    s_add_u32 s9, s62, 0
    buffer_load_dwordx4 v[96:99], v2, s[48:51], s9 offen
    s_add_u32 s9, s62, 44032
    buffer_load_dwordx4 v[100:103], v2, s[48:51], s9 offen
    s_add_u32 s9, s62, 88064
    buffer_load_dwordx4 v[104:107], v2, s[48:51], s9 offen
    s_add_u32 s9, s62, 132096
    buffer_load_dwordx4 v[108:111], v2, s[48:51], s9 offen
    s_add_u32 s60, s60, 512
    s_cmp_eq_u32 s60, 5632
    s_cselect_b32 s60, 0, s60
    s_waitcnt vmcnt(41)
    ds_read_b64_tr_b16 v[128:129], v8 offset:0
    ds_read_b64_tr_b16 v[130:131], v8 offset:512
    ds_read_b64_tr_b16 v[132:133], v9 offset:0
    ds_read_b64_tr_b16 v[134:135], v9 offset:512
    ds_read_b64_tr_b16 v[136:137], v10 offset:0
    ds_read_b64_tr_b16 v[138:139], v10 offset:512
    ds_read_b64_tr_b16 v[140:141], v11 offset:0
    ds_read_b64_tr_b16 v[142:143], v11 offset:512
    s_waitcnt lgkmcnt(0)
    s_waitcnt vmcnt(8)
    s_waitcnt vmcnt(37)
    v_mfma_f32_16x16x32_bf16 a[0:3], v[64:67], v[128:131], 0
    v_mfma_f32_16x16x32_bf16 a[4:7], v[64:67], v[132:135], 0
    ds_read_b64_tr_b16 v[144:145], v8 offset:4096
    ds_read_b64_tr_b16 v[146:147], v8 offset:4608
    v_mfma_f32_16x16x32_bf16 a[8:11], v[64:67], v[136:139], 0
    ds_read_b64_tr_b16 v[148:149], v9 offset:4096
    ds_read_b64_tr_b16 v[150:151], v9 offset:4608
    v_mfma_f32_16x16x32_bf16 a[12:15], v[64:67], v[140:143], 0
    ds_read_b64_tr_b16 v[152:153], v10 offset:4096
    ds_read_b64_tr_b16 v[154:155], v10 offset:4608
    v_mfma_f32_16x16x32_bf16 a[16:19], v[68:71], v[128:131], 0
    v_mfma_f32_16x16x32_bf16 a[20:23], v[68:71], v[132:135], 0
    ds_read_b64_tr_b16 v[156:157], v11 offset:4096
    ds_read_b64_tr_b16 v[158:159], v11 offset:4608
    v_mfma_f32_16x16x32_bf16 a[24:27], v[68:71], v[136:139], 0
    s_lshl_b32 s62, s60, 3
    s_add_u32 s62, s62, s56
    s_cmp_eq_u32 s60, 5120
    s_cselect_b32 s8, s63, 0
    s_add_u32 s62, s62, s8
    s_add_u32 s9, s62, 0
    buffer_load_dwordx4 v[112:115], v2, s[48:51], s9 offen
    v_mfma_f32_16x16x32_bf16 a[28:31], v[68:71], v[140:143], 0
    s_add_u32 s9, s62, 44032
    buffer_load_dwordx4 v[116:119], v2, s[48:51], s9 offen
    v_mfma_f32_16x16x32_bf16 a[32:35], v[72:75], v[128:131], 0
    v_mfma_f32_16x16x32_bf16 a[36:39], v[72:75], v[132:135], 0
    s_add_u32 s9, s62, 88064
    buffer_load_dwordx4 v[120:123], v2, s[48:51], s9 offen
    v_mfma_f32_16x16x32_bf16 a[40:43], v[72:75], v[136:139], 0
    s_add_u32 s9, s62, 132096
    buffer_load_dwordx4 v[124:127], v2, s[48:51], s9 offen
    s_add_u32 s60, s60, 512
    s_cmp_eq_u32 s60, 5632
    s_cselect_b32 s60, 0, s60
    v_mfma_f32_16x16x32_bf16 a[44:47], v[72:75], v[140:143], 0
    s_mul_i32 s62, s61, 688
    s_add_u32 s62, s62, s57
    s_add_u32 m0, s59, 0
    s_add_u32 s58, s62, 0
    buffer_load_dwordx4 v6, s[40:43], s58 offen offset:0 lds
    v_mfma_f32_16x16x32_bf16 a[48:51], v[76:79], v[128:131], 0
    v_mfma_f32_16x16x32_bf16 a[52:55], v[76:79], v[132:135], 0
    s_add_u32 s58, s62, 20992
    buffer_load_dwordx4 v7, s[40:43], s58 offen offset:1024 lds
    v_mfma_f32_16x16x32_bf16 a[56:59], v[76:79], v[136:139], 0
    s_add_u32 s58, s62, 41984
    buffer_load_dwordx4 v6, s[40:43], s58 offen offset:2048 lds
    v_mfma_f32_16x16x32_bf16 a[60:63], v[76:79], v[140:143], 0
    s_add_u32 s58, s62, 62976
    buffer_load_dwordx4 v7, s[40:43], s58 offen offset:3072 lds
    s_add_u32 s61, s61, 512
    s_cmp_eq_u32 s61, 5632
    s_cselect_b32 s61, 0, s61
    s_waitcnt lgkmcnt(0)
    s_waitcnt vmcnt(12)
    s_waitcnt vmcnt(41)
    v_mfma_f32_16x16x32_bf16 a[0:3], v[80:83], v[144:147], a[0:3]
    v_mfma_f32_16x16x32_bf16 a[4:7], v[80:83], v[148:151], a[4:7]
    ds_read_b64_tr_b16 v[128:129], v8 offset:8192
    ds_read_b64_tr_b16 v[130:131], v8 offset:8704
    v_mfma_f32_16x16x32_bf16 a[8:11], v[80:83], v[152:155], a[8:11]
    ds_read_b64_tr_b16 v[132:133], v9 offset:8192
    ds_read_b64_tr_b16 v[134:135], v9 offset:8704
    v_mfma_f32_16x16x32_bf16 a[12:15], v[80:83], v[156:159], a[12:15]
    ds_read_b64_tr_b16 v[136:137], v10 offset:8192
    ds_read_b64_tr_b16 v[138:139], v10 offset:8704
    v_mfma_f32_16x16x32_bf16 a[16:19], v[84:87], v[144:147], a[16:19]
    v_mfma_f32_16x16x32_bf16 a[20:23], v[84:87], v[148:151], a[20:23]
    ds_read_b64_tr_b16 v[140:141], v11 offset:8192
    ds_read_b64_tr_b16 v[142:143], v11 offset:8704
    v_mfma_f32_16x16x32_bf16 a[24:27], v[84:87], v[152:155], a[24:27]
    s_lshl_b32 s62, s60, 3
    s_add_u32 s62, s62, s56
    s_cmp_eq_u32 s60, 5120
    s_cselect_b32 s8, s63, 0
    s_add_u32 s62, s62, s8
    s_add_u32 s9, s62, 0
    buffer_load_dwordx4 v[64:67], v2, s[48:51], s9 offen
    v_mfma_f32_16x16x32_bf16 a[28:31], v[84:87], v[156:159], a[28:31]
    s_add_u32 s9, s62, 44032
    buffer_load_dwordx4 v[68:71], v2, s[48:51], s9 offen
    v_mfma_f32_16x16x32_bf16 a[32:35], v[88:91], v[144:147], a[32:35]
    v_mfma_f32_16x16x32_bf16 a[36:39], v[88:91], v[148:151], a[36:39]
    s_add_u32 s9, s62, 88064
    buffer_load_dwordx4 v[72:75], v2, s[48:51], s9 offen
    v_mfma_f32_16x16x32_bf16 a[40:43], v[88:91], v[152:155], a[40:43]
    s_add_u32 s9, s62, 132096
    buffer_load_dwordx4 v[76:79], v2, s[48:51], s9 offen
    s_add_u32 s60, s60, 512
    s_cmp_eq_u32 s60, 5632
    s_cselect_b32 s60, 0, s60
    v_mfma_f32_16x16x32_bf16 a[44:47], v[88:91], v[156:159], a[44:47]
    s_mul_i32 s62, s61, 688
    s_add_u32 s62, s62, s57
    s_add_u32 m0, s59, 4096
    s_add_u32 s58, s62, 0
    buffer_load_dwordx4 v6, s[40:43], s58 offen offset:0 lds
    v_mfma_f32_16x16x32_bf16 a[48:51], v[92:95], v[144:147], a[48:51]
    v_mfma_f32_16x16x32_bf16 a[52:55], v[92:95], v[148:151], a[52:55]
    s_add_u32 s58, s62, 20992
    buffer_load_dwordx4 v7, s[40:43], s58 offen offset:1024 lds
    v_mfma_f32_16x16x32_bf16 a[56:59], v[92:95], v[152:155], a[56:59]
    s_add_u32 s58, s62, 41984
    buffer_load_dwordx4 v6, s[40:43], s58 offen offset:2048 lds
    v_mfma_f32_16x16x32_bf16 a[60:63], v[92:95], v[156:159], a[60:63]
    s_add_u32 s58, s62, 62976
    buffer_load_dwordx4 v7, s[40:43], s58 offen offset:3072 lds
    s_add_u32 s61, s61, 512
    s_cmp_eq_u32 s61, 5632
    s_cselect_b32 s61, 0, s61
    s_waitcnt lgkmcnt(0)
    s_waitcnt vmcnt(16)
    s_waitcnt vmcnt(45)
    v_mfma_f32_16x16x32_bf16 a[0:3], v[96:99], v[128:131], a[0:3]
    v_mfma_f32_16x16x32_bf16 a[4:7], v[96:99], v[132:135], a[4:7]
    ds_read_b64_tr_b16 v[144:145], v8 offset:12288
    ds_read_b64_tr_b16 v[146:147], v8 offset:12800
    v_mfma_f32_16x16x32_bf16 a[8:11], v[96:99], v[136:139], a[8:11]
    ds_read_b64_tr_b16 v[148:149], v9 offset:12288
    ds_read_b64_tr_b16 v[150:151], v9 offset:12800
    v_mfma_f32_16x16x32_bf16 a[12:15], v[96:99], v[140:143], a[12:15]
    ds_read_b64_tr_b16 v[152:153], v10 offset:12288
    ds_read_b64_tr_b16 v[154:155], v10 offset:12800
    v_mfma_f32_16x16x32_bf16 a[16:19], v[100:103], v[128:131], a[16:19]
    v_mfma_f32_16x16x32_bf16 a[20:23], v[100:103], v[132:135], a[20:23]
    ds_read_b64_tr_b16 v[156:157], v11 offset:12288
    ds_read_b64_tr_b16 v[158:159], v11 offset:12800
    v_mfma_f32_16x16x32_bf16 a[24:27], v[100:103], v[136:139], a[24:27]
    s_lshl_b32 s62, s60, 3
    s_add_u32 s62, s62, s56
    s_cmp_eq_u32 s60, 5120
    s_cselect_b32 s8, s63, 0
    s_add_u32 s62, s62, s8
    s_add_u32 s9, s62, 0
    buffer_load_dwordx4 v[80:83], v2, s[48:51], s9 offen
    v_mfma_f32_16x16x32_bf16 a[28:31], v[100:103], v[140:143], a[28:31]
    s_add_u32 s9, s62, 44032
    buffer_load_dwordx4 v[84:87], v2, s[48:51], s9 offen
    v_mfma_f32_16x16x32_bf16 a[32:35], v[104:107], v[128:131], a[32:35]
    v_mfma_f32_16x16x32_bf16 a[36:39], v[104:107], v[132:135], a[36:39]
    s_add_u32 s9, s62, 88064
    buffer_load_dwordx4 v[88:91], v2, s[48:51], s9 offen
    v_mfma_f32_16x16x32_bf16 a[40:43], v[104:107], v[136:139], a[40:43]
    s_add_u32 s9, s62, 132096
    buffer_load_dwordx4 v[92:95], v2, s[48:51], s9 offen
    s_add_u32 s60, s60, 512
    s_cmp_eq_u32 s60, 5632
    s_cselect_b32 s60, 0, s60
    v_mfma_f32_16x16x32_bf16 a[44:47], v[104:107], v[140:143], a[44:47]
    s_mul_i32 s62, s61, 688
    s_add_u32 s62, s62, s57
    s_add_u32 m0, s59, 8192
    s_add_u32 s58, s62, 0
    buffer_load_dwordx4 v6, s[40:43], s58 offen offset:0 lds
    v_mfma_f32_16x16x32_bf16 a[48:51], v[108:111], v[128:131], a[48:51]
    v_mfma_f32_16x16x32_bf16 a[52:55], v[108:111], v[132:135], a[52:55]
    s_add_u32 s58, s62, 20992
    buffer_load_dwordx4 v7, s[40:43], s58 offen offset:1024 lds
    v_mfma_f32_16x16x32_bf16 a[56:59], v[108:111], v[136:139], a[56:59]
    s_add_u32 s58, s62, 41984
    buffer_load_dwordx4 v6, s[40:43], s58 offen offset:2048 lds
    v_mfma_f32_16x16x32_bf16 a[60:63], v[108:111], v[140:143], a[60:63]
    s_add_u32 s58, s62, 62976
    buffer_load_dwordx4 v7, s[40:43], s58 offen offset:3072 lds
    s_add_u32 s61, s61, 512
    s_cmp_eq_u32 s61, 5632
    s_cselect_b32 s61, 0, s61
    s_waitcnt lgkmcnt(0)
    s_waitcnt vmcnt(20)
    s_waitcnt vmcnt(49)
    v_mfma_f32_16x16x32_bf16 a[0:3], v[112:115], v[144:147], a[0:3]
    v_mfma_f32_16x16x32_bf16 a[4:7], v[112:115], v[148:151], a[4:7]
    ds_read_b64_tr_b16 v[128:129], v8 offset:16384
    ds_read_b64_tr_b16 v[130:131], v8 offset:16896
    v_mfma_f32_16x16x32_bf16 a[8:11], v[112:115], v[152:155], a[8:11]
    v_mfma_f32_16x16x32_bf16 a[12:15], v[112:115], v[156:159], a[12:15]
    ds_read_b64_tr_b16 v[132:133], v9 offset:16384
    ds_read_b64_tr_b16 v[134:135], v9 offset:16896
    v_mfma_f32_16x16x32_bf16 a[16:19], v[116:119], v[144:147], a[16:19]
    v_mfma_f32_16x16x32_bf16 a[20:23], v[116:119], v[148:151], a[20:23]
    ds_read_b64_tr_b16 v[136:137], v10 offset:16384
    ds_read_b64_tr_b16 v[138:139], v10 offset:16896
    v_mfma_f32_16x16x32_bf16 a[24:27], v[116:119], v[152:155], a[24:27]
    v_mfma_f32_16x16x32_bf16 a[28:31], v[116:119], v[156:159], a[28:31]
    ds_read_b64_tr_b16 v[140:141], v11 offset:16384
    ds_read_b64_tr_b16 v[142:143], v11 offset:16896
    v_mfma_f32_16x16x32_bf16 a[32:35], v[120:123], v[144:147], a[32:35]
    v_mfma_f32_16x16x32_bf16 a[36:39], v[120:123], v[148:151], a[36:39]
    s_lshl_b32 s62, s60, 3
    s_add_u32 s62, s62, s56
    s_cmp_eq_u32 s60, 5120
    s_cselect_b32 s8, s63, 0
    s_add_u32 s62, s62, s8
    s_add_u32 s9, s62, 0
    buffer_load_dwordx4 v[96:99], v2, s[48:51], s9 offen
    v_mfma_f32_16x16x32_bf16 a[40:43], v[120:123], v[152:155], a[40:43]
    v_mfma_f32_16x16x32_bf16 a[44:47], v[120:123], v[156:159], a[44:47]
    s_add_u32 s9, s62, 44032
    buffer_load_dwordx4 v[100:103], v2, s[48:51], s9 offen
    v_mfma_f32_16x16x32_bf16 a[48:51], v[124:127], v[144:147], a[48:51]
    v_mfma_f32_16x16x32_bf16 a[52:55], v[124:127], v[148:151], a[52:55]
    s_add_u32 s9, s62, 88064
    buffer_load_dwordx4 v[104:107], v2, s[48:51], s9 offen
    v_mfma_f32_16x16x32_bf16 a[56:59], v[124:127], v[152:155], a[56:59]
    v_mfma_f32_16x16x32_bf16 a[60:63], v[124:127], v[156:159], a[60:63]
    s_add_u32 s9, s62, 132096
    buffer_load_dwordx4 v[108:111], v2, s[48:51], s9 offen
    s_add_u32 s60, s60, 512
    s_cmp_eq_u32 s60, 5632
    s_cselect_b32 s60, 0, s60
    s_waitcnt lgkmcnt(0)
    s_waitcnt vmcnt(16)
    s_waitcnt vmcnt(49)
    v_mfma_f32_16x16x32_bf16 a[0:3], v[64:67], v[128:131], a[0:3]
    v_mfma_f32_16x16x32_bf16 a[4:7], v[64:67], v[132:135], a[4:7]
    ds_read_b64_tr_b16 v[144:145], v8 offset:20480
    ds_read_b64_tr_b16 v[146:147], v8 offset:20992
    v_mfma_f32_16x16x32_bf16 a[8:11], v[64:67], v[136:139], a[8:11]
    v_mfma_f32_16x16x32_bf16 a[12:15], v[64:67], v[140:143], a[12:15]
    ds_read_b64_tr_b16 v[148:149], v9 offset:20480
    ds_read_b64_tr_b16 v[150:151], v9 offset:20992
    v_mfma_f32_16x16x32_bf16 a[16:19], v[68:71], v[128:131], a[16:19]
    v_mfma_f32_16x16x32_bf16 a[20:23], v[68:71], v[132:135], a[20:23]
    ds_read_b64_tr_b16 v[152:153], v10 offset:20480
    ds_read_b64_tr_b16 v[154:155], v10 offset:20992
    v_mfma_f32_16x16x32_bf16 a[24:27], v[68:71], v[136:139], a[24:27]
    v_mfma_f32_16x16x32_bf16 a[28:31], v[68:71], v[140:143], a[28:31]
    ds_read_b64_tr_b16 v[156:157], v11 offset:20480
    ds_read_b64_tr_b16 v[158:159], v11 offset:20992
    v_mfma_f32_16x16x32_bf16 a[32:35], v[72:75], v[128:131], a[32:35]
    v_mfma_f32_16x16x32_bf16 a[36:39], v[72:75], v[132:135], a[36:39]
    s_lshl_b32 s62, s60, 3
    s_add_u32 s62, s62, s56
    s_cmp_eq_u32 s60, 5120
    s_cselect_b32 s8, s63, 0
    s_add_u32 s62, s62, s8
    s_add_u32 s9, s62, 0
    buffer_load_dwordx4 v[112:115], v2, s[48:51], s9 offen
    v_mfma_f32_16x16x32_bf16 a[40:43], v[72:75], v[136:139], a[40:43]
    v_mfma_f32_16x16x32_bf16 a[44:47], v[72:75], v[140:143], a[44:47]
    s_add_u32 s9, s62, 44032
    buffer_load_dwordx4 v[116:119], v2, s[48:51], s9 offen
    v_mfma_f32_16x16x32_bf16 a[48:51], v[76:79], v[128:131], a[48:51]
    v_mfma_f32_16x16x32_bf16 a[52:55], v[76:79], v[132:135], a[52:55]
    s_add_u32 s9, s62, 88064
    buffer_load_dwordx4 v[120:123], v2, s[48:51], s9 offen
    v_mfma_f32_16x16x32_bf16 a[56:59], v[76:79], v[136:139], a[56:59]
    v_mfma_f32_16x16x32_bf16 a[60:63], v[76:79], v[140:143], a[60:63]
    s_add_u32 s9, s62, 132096
    buffer_load_dwordx4 v[124:127], v2, s[48:51], s9 offen
    s_add_u32 s60, s60, 512
    s_cmp_eq_u32 s60, 5632
    s_cselect_b32 s60, 0, s60
    s_waitcnt lgkmcnt(0)
    s_waitcnt vmcnt(12)
    s_waitcnt vmcnt(49)
    v_mfma_f32_16x16x32_bf16 a[0:3], v[80:83], v[144:147], a[0:3]
    v_mfma_f32_16x16x32_bf16 a[4:7], v[80:83], v[148:151], a[4:7]
    ds_read_b64_tr_b16 v[128:129], v8 offset:24576
    ds_read_b64_tr_b16 v[130:131], v8 offset:25088
    v_mfma_f32_16x16x32_bf16 a[8:11], v[80:83], v[152:155], a[8:11]
    v_mfma_f32_16x16x32_bf16 a[12:15], v[80:83], v[156:159], a[12:15]
    ds_read_b64_tr_b16 v[132:133], v9 offset:24576
    ds_read_b64_tr_b16 v[134:135], v9 offset:25088
    v_mfma_f32_16x16x32_bf16 a[16:19], v[84:87], v[144:147], a[16:19]
    v_mfma_f32_16x16x32_bf16 a[20:23], v[84:87], v[148:151], a[20:23]
    ds_read_b64_tr_b16 v[136:137], v10 offset:24576
    ds_read_b64_tr_b16 v[138:139], v10 offset:25088
    v_mfma_f32_16x16x32_bf16 a[24:27], v[84:87], v[152:155], a[24:27]
    v_mfma_f32_16x16x32_bf16 a[28:31], v[84:87], v[156:159], a[28:31]
    ds_read_b64_tr_b16 v[140:141], v11 offset:24576
    ds_read_b64_tr_b16 v[142:143], v11 offset:25088
    v_mfma_f32_16x16x32_bf16 a[32:35], v[88:91], v[144:147], a[32:35]
    v_mfma_f32_16x16x32_bf16 a[36:39], v[88:91], v[148:151], a[36:39]
    s_lshl_b32 s62, s60, 3
    s_add_u32 s62, s62, s56
    s_cmp_eq_u32 s60, 5120
    s_cselect_b32 s8, s63, 0
    s_add_u32 s62, s62, s8
    s_add_u32 s9, s62, 0
    buffer_load_dwordx4 v[64:67], v2, s[48:51], s9 offen
    v_mfma_f32_16x16x32_bf16 a[40:43], v[88:91], v[152:155], a[40:43]
    v_mfma_f32_16x16x32_bf16 a[44:47], v[88:91], v[156:159], a[44:47]
    s_add_u32 s9, s62, 44032
    buffer_load_dwordx4 v[68:71], v2, s[48:51], s9 offen
    v_mfma_f32_16x16x32_bf16 a[48:51], v[92:95], v[144:147], a[48:51]
    v_mfma_f32_16x16x32_bf16 a[52:55], v[92:95], v[148:151], a[52:55]
    s_add_u32 s9, s62, 88064
    buffer_load_dwordx4 v[72:75], v2, s[48:51], s9 offen
    v_mfma_f32_16x16x32_bf16 a[56:59], v[92:95], v[152:155], a[56:59]
    v_mfma_f32_16x16x32_bf16 a[60:63], v[92:95], v[156:159], a[60:63]
    s_add_u32 s9, s62, 132096
    buffer_load_dwordx4 v[76:79], v2, s[48:51], s9 offen
    s_add_u32 s60, s60, 512
    s_cmp_eq_u32 s60, 5632
    s_cselect_b32 s60, 0, s60
    s_waitcnt lgkmcnt(0)
    s_waitcnt vmcnt(8)
    s_waitcnt vmcnt(49)
    v_mfma_f32_16x16x32_bf16 a[0:3], v[96:99], v[128:131], a[0:3]
    v_mfma_f32_16x16x32_bf16 a[4:7], v[96:99], v[132:135], a[4:7]
    ds_read_b64_tr_b16 v[144:145], v8 offset:28672
    ds_read_b64_tr_b16 v[146:147], v8 offset:29184
    v_mfma_f32_16x16x32_bf16 a[8:11], v[96:99], v[136:139], a[8:11]
    v_mfma_f32_16x16x32_bf16 a[12:15], v[96:99], v[140:143], a[12:15]
    ds_read_b64_tr_b16 v[148:149], v9 offset:28672
    ds_read_b64_tr_b16 v[150:151], v9 offset:29184
    v_mfma_f32_16x16x32_bf16 a[16:19], v[100:103], v[128:131], a[16:19]
    v_mfma_f32_16x16x32_bf16 a[20:23], v[100:103], v[132:135], a[20:23]
    ds_read_b64_tr_b16 v[152:153], v10 offset:28672
    ds_read_b64_tr_b16 v[154:155], v10 offset:29184
    v_mfma_f32_16x16x32_bf16 a[24:27], v[100:103], v[136:139], a[24:27]
    v_mfma_f32_16x16x32_bf16 a[28:31], v[100:103], v[140:143], a[28:31]
    ds_read_b64_tr_b16 v[156:157], v11 offset:28672
    ds_read_b64_tr_b16 v[158:159], v11 offset:29184
    v_mfma_f32_16x16x32_bf16 a[32:35], v[104:107], v[128:131], a[32:35]
    v_mfma_f32_16x16x32_bf16 a[36:39], v[104:107], v[132:135], a[36:39]
    s_lshl_b32 s62, s60, 3
    s_add_u32 s62, s62, s56
    s_cmp_eq_u32 s60, 5120
    s_cselect_b32 s8, s63, 0
    s_add_u32 s62, s62, s8
    s_add_u32 s9, s62, 0
    buffer_load_dwordx4 v[80:83], v2, s[48:51], s9 offen
    v_mfma_f32_16x16x32_bf16 a[40:43], v[104:107], v[136:139], a[40:43]
    v_mfma_f32_16x16x32_bf16 a[44:47], v[104:107], v[140:143], a[44:47]
    s_add_u32 s9, s62, 44032
    buffer_load_dwordx4 v[84:87], v2, s[48:51], s9 offen
    v_mfma_f32_16x16x32_bf16 a[48:51], v[108:111], v[128:131], a[48:51]
    v_mfma_f32_16x16x32_bf16 a[52:55], v[108:111], v[132:135], a[52:55]
    s_add_u32 s9, s62, 88064
    buffer_load_dwordx4 v[88:91], v2, s[48:51], s9 offen
    v_mfma_f32_16x16x32_bf16 a[56:59], v[108:111], v[136:139], a[56:59]
    v_mfma_f32_16x16x32_bf16 a[60:63], v[108:111], v[140:143], a[60:63]
    s_add_u32 s9, s62, 132096
    buffer_load_dwordx4 v[92:95], v2, s[48:51], s9 offen
    s_add_u32 s60, s60, 512
    s_cmp_eq_u32 s60, 5632
    s_cselect_b32 s60, 0, s60
    s_waitcnt lgkmcnt(0)
    s_waitcnt vmcnt(8)
    s_waitcnt vmcnt(32)
    v_mfma_f32_16x16x32_bf16 a[0:3], v[112:115], v[144:147], a[0:3]
    v_mfma_f32_16x16x32_bf16 a[4:7], v[112:115], v[148:151], a[4:7]
    ds_read_b64_tr_b16 v[128:129], v8 offset:0
    ds_read_b64_tr_b16 v[130:131], v8 offset:512
    v_mfma_f32_16x16x32_bf16 a[8:11], v[112:115], v[152:155], a[8:11]
    v_mfma_f32_16x16x32_bf16 a[12:15], v[112:115], v[156:159], a[12:15]
    ds_read_b64_tr_b16 v[132:133], v9 offset:0
    ds_read_b64_tr_b16 v[134:135], v9 offset:512
    v_mfma_f32_16x16x32_bf16 a[16:19], v[116:119], v[144:147], a[16:19]
    v_mfma_f32_16x16x32_bf16 a[20:23], v[116:119], v[148:151], a[20:23]
    ds_read_b64_tr_b16 v[136:137], v10 offset:0
    ds_read_b64_tr_b16 v[138:139], v10 offset:512
    v_mfma_f32_16x16x32_bf16 a[24:27], v[116:119], v[152:155], a[24:27]
    v_mfma_f32_16x16x32_bf16 a[28:31], v[116:119], v[156:159], a[28:31]
    ds_read_b64_tr_b16 v[140:141], v11 offset:0
    ds_read_b64_tr_b16 v[142:143], v11 offset:512
    v_mfma_f32_16x16x32_bf16 a[32:35], v[120:123], v[144:147], a[32:35]
    v_mfma_f32_16x16x32_bf16 a[36:39], v[120:123], v[148:151], a[36:39]
    s_lshl_b32 s62, s60, 3
    s_add_u32 s62, s62, s56
    s_cmp_eq_u32 s60, 5120
    s_cselect_b32 s8, s63, 0
    s_add_u32 s62, s62, s8
    s_add_u32 s9, s62, 0
    buffer_load_dwordx4 v[96:99], v2, s[48:51], s9 offen
    v_mfma_f32_16x16x32_bf16 a[40:43], v[120:123], v[152:155], a[40:43]
    v_mfma_f32_16x16x32_bf16 a[44:47], v[120:123], v[156:159], a[44:47]
    s_add_u32 s9, s62, 44032
    buffer_load_dwordx4 v[100:103], v2, s[48:51], s9 offen
    v_mfma_f32_16x16x32_bf16 a[48:51], v[124:127], v[144:147], a[48:51]
    v_mfma_f32_16x16x32_bf16 a[52:55], v[124:127], v[148:151], a[52:55]
    s_add_u32 s9, s62, 88064
    buffer_load_dwordx4 v[104:107], v2, s[48:51], s9 offen
    v_mfma_f32_16x16x32_bf16 a[56:59], v[124:127], v[152:155], a[56:59]
    v_mfma_f32_16x16x32_bf16 a[60:63], v[124:127], v[156:159], a[60:63]
    s_add_u32 s9, s62, 132096
    buffer_load_dwordx4 v[108:111], v2, s[48:51], s9 offen
    s_add_u32 s60, s60, 512
    s_cmp_eq_u32 s60, 5632
    s_cselect_b32 s60, 0, s60
    s_waitcnt lgkmcnt(0)
    s_waitcnt vmcnt(8)
    s_waitcnt vmcnt(28)
    v_mfma_f32_16x16x32_bf16 a[0:3], v[64:67], v[128:131], a[0:3]
    v_mfma_f32_16x16x32_bf16 a[4:7], v[64:67], v[132:135], a[4:7]
    v_mfma_f32_16x16x32_bf16 a[8:11], v[64:67], v[136:139], a[8:11]
    v_mfma_f32_16x16x32_bf16 a[12:15], v[64:67], v[140:143], a[12:15]
    ds_read_b64_tr_b16 v[144:145], v8 offset:4096
    ds_read_b64_tr_b16 v[146:147], v8 offset:4608
    v_mfma_f32_16x16x32_bf16 a[16:19], v[68:71], v[128:131], a[16:19]
    v_mfma_f32_16x16x32_bf16 a[20:23], v[68:71], v[132:135], a[20:23]
    v_mfma_f32_16x16x32_bf16 a[24:27], v[68:71], v[136:139], a[24:27]
    v_mfma_f32_16x16x32_bf16 a[28:31], v[68:71], v[140:143], a[28:31]
    ds_read_b64_tr_b16 v[148:149], v9 offset:4096
    ds_read_b64_tr_b16 v[150:151], v9 offset:4608
    v_mfma_f32_16x16x32_bf16 a[32:35], v[72:75], v[128:131], a[32:35]
    v_mfma_f32_16x16x32_bf16 a[36:39], v[72:75], v[132:135], a[36:39]
    v_mfma_f32_16x16x32_bf16 a[40:43], v[72:75], v[136:139], a[40:43]
    v_mfma_f32_16x16x32_bf16 a[44:47], v[72:75], v[140:143], a[44:47]
    ds_read_b64_tr_b16 v[152:153], v10 offset:4096
    ds_read_b64_tr_b16 v[154:155], v10 offset:4608
    v_mfma_f32_16x16x32_bf16 a[48:51], v[76:79], v[128:131], a[48:51]
    v_mfma_f32_16x16x32_bf16 a[52:55], v[76:79], v[132:135], a[52:55]
    v_mfma_f32_16x16x32_bf16 a[56:59], v[76:79], v[136:139], a[56:59]
    v_mfma_f32_16x16x32_bf16 a[60:63], v[76:79], v[140:143], a[60:63]
    ds_read_b64_tr_b16 v[156:157], v11 offset:4096
    ds_read_b64_tr_b16 v[158:159], v11 offset:4608
    s_waitcnt lgkmcnt(0)
    s_waitcnt vmcnt(4)
    s_waitcnt vmcnt(20)
    v_mfma_f32_16x16x32_bf16 a[0:3], v[80:83], v[144:147], a[0:3]
    v_mfma_f32_16x16x32_bf16 a[4:7], v[80:83], v[148:151], a[4:7]
    v_mfma_f32_16x16x32_bf16 a[8:11], v[80:83], v[152:155], a[8:11]
    v_mfma_f32_16x16x32_bf16 a[12:15], v[80:83], v[156:159], a[12:15]
    ds_read_b64_tr_b16 v[128:129], v8 offset:8192
    ds_read_b64_tr_b16 v[130:131], v8 offset:8704
    v_mfma_f32_16x16x32_bf16 a[16:19], v[84:87], v[144:147], a[16:19]
    v_mfma_f32_16x16x32_bf16 a[20:23], v[84:87], v[148:151], a[20:23]
    v_mfma_f32_16x16x32_bf16 a[24:27], v[84:87], v[152:155], a[24:27]
    v_mfma_f32_16x16x32_bf16 a[28:31], v[84:87], v[156:159], a[28:31]
    ds_read_b64_tr_b16 v[132:133], v9 offset:8192
    ds_read_b64_tr_b16 v[134:135], v9 offset:8704
    v_mfma_f32_16x16x32_bf16 a[32:35], v[88:91], v[144:147], a[32:35]
    v_mfma_f32_16x16x32_bf16 a[36:39], v[88:91], v[148:151], a[36:39]
    v_mfma_f32_16x16x32_bf16 a[40:43], v[88:91], v[152:155], a[40:43]
    v_mfma_f32_16x16x32_bf16 a[44:47], v[88:91], v[156:159], a[44:47]
    ds_read_b64_tr_b16 v[136:137], v10 offset:8192
    ds_read_b64_tr_b16 v[138:139], v10 offset:8704
    v_mfma_f32_16x16x32_bf16 a[48:51], v[92:95], v[144:147], a[48:51]
    v_mfma_f32_16x16x32_bf16 a[52:55], v[92:95], v[148:151], a[52:55]
    v_mfma_f32_16x16x32_bf16 a[56:59], v[92:95], v[152:155], a[56:59]
    v_mfma_f32_16x16x32_bf16 a[60:63], v[92:95], v[156:159], a[60:63]
    ds_read_b64_tr_b16 v[140:141], v11 offset:8192
    ds_read_b64_tr_b16 v[142:143], v11 offset:8704
    s_waitcnt lgkmcnt(0)
    s_waitcnt vmcnt(0)
    v_mfma_f32_16x16x32_bf16 a[0:3], v[96:99], v[128:131], a[0:3]
    v_mfma_f32_16x16x32_bf16 a[4:7], v[96:99], v[132:135], a[4:7]
    v_mfma_f32_16x16x32_bf16 a[8:11], v[96:99], v[136:139], a[8:11]
    v_mfma_f32_16x16x32_bf16 a[12:15], v[96:99], v[140:143], a[12:15]
    v_mfma_f32_16x16x32_bf16 a[16:19], v[100:103], v[128:131], a[16:19]
    v_mfma_f32_16x16x32_bf16 a[20:23], v[100:103], v[132:135], a[20:23]
    v_mfma_f32_16x16x32_bf16 a[24:27], v[100:103], v[136:139], a[24:27]
    v_mfma_f32_16x16x32_bf16 a[28:31], v[100:103], v[140:143], a[28:31]
    v_mfma_f32_16x16x32_bf16 a[32:35], v[104:107], v[128:131], a[32:35]
    v_mfma_f32_16x16x32_bf16 a[36:39], v[104:107], v[132:135], a[36:39]
    v_mfma_f32_16x16x32_bf16 a[40:43], v[104:107], v[136:139], a[40:43]
    v_mfma_f32_16x16x32_bf16 a[44:47], v[104:107], v[140:143], a[44:47]
    v_mfma_f32_16x16x32_bf16 a[48:51], v[108:111], v[128:131], a[48:51]
    v_mfma_f32_16x16x32_bf16 a[52:55], v[108:111], v[132:135], a[52:55]
    v_mfma_f32_16x16x32_bf16 a[56:59], v[108:111], v[136:139], a[56:59]
    v_mfma_f32_16x16x32_bf16 a[60:63], v[108:111], v[140:143], a[60:63]
    s_add_u32 s20, s32, 0x360000
    s_addc_u32 s21, s33, 0
    s_and_b32 s21, s21, 0xffff
    s_mov_b32 s22, 0x4000
    s_mov_b32 s23, 0x20000
    v_mov_b32 v211, 0
    buffer_load_dword v209, v211, s[92:95], 0 offen sc1
    s_add_u32 s8, s34, 32
    s_lshl_b32 s8, s8, 7
    v_and_b32 v212, 3, v1
    v_lshl_add_u32 v212, v212, 2, s8
    buffer_load_dword v210, v212, s[20:23], 0 offen sc1
    v_add_u32 v3, s59, v2
    s_add_u32 s14, s3, 1
    s_and_b32 s14, s14, 3
    s_lshl_b32 s14, s14, 15
    s_lshl_b32 s13, s3, 12
    s_add_u32 s14, s14, s13
    v_add_u32 v9, s14, v2
    s_add_u32 s14, s3, 2
    s_and_b32 s14, s14, 3
    s_lshl_b32 s14, s14, 15
    s_lshl_b32 s13, s3, 12
    s_add_u32 s14, s14, s13
    v_add_u32 v10, s14, v2
    s_add_u32 s14, s3, 3
    s_and_b32 s14, s14, 3
    s_lshl_b32 s14, s14, 15
    s_lshl_b32 s13, s3, 12
    s_add_u32 s14, s14, s13
    v_add_u32 v11, s14, v2
    s_nop 4
    s_cmp_eq_u32 s3, 0
    s_cbranch_scc1 Kb_own0
    ds_write_b128 v3, a[0:3] offset:0
    ds_write_b128 v3, a[16:19] offset:1024
    ds_write_b128 v3, a[32:35] offset:2048
    ds_write_b128 v3, a[48:51] offset:3072
    s_branch Kb_next0
Kb_own0:
    v_accvgpr_read_b32 v48, a0
    v_accvgpr_read_b32 v49, a1
    v_accvgpr_read_b32 v50, a2
    v_accvgpr_read_b32 v51, a3
    v_accvgpr_read_b32 v52, a16
    v_accvgpr_read_b32 v53, a17
    v_accvgpr_read_b32 v54, a18
    v_accvgpr_read_b32 v55, a19
    v_accvgpr_read_b32 v56, a32
    v_accvgpr_read_b32 v57, a33
    v_accvgpr_read_b32 v58, a34
    v_accvgpr_read_b32 v59, a35
    v_accvgpr_read_b32 v60, a48
    v_accvgpr_read_b32 v61, a49
    v_accvgpr_read_b32 v62, a50
    v_accvgpr_read_b32 v63, a51
Kb_next0:
    s_cmp_eq_u32 s3, 1
    s_cbranch_scc1 Kb_own1
    ds_write_b128 v3, a[4:7] offset:4096
    ds_write_b128 v3, a[20:23] offset:5120
    ds_write_b128 v3, a[36:39] offset:6144
    ds_write_b128 v3, a[52:55] offset:7168
    s_branch Kb_next1
Kb_own1:
    v_accvgpr_read_b32 v48, a4
    v_accvgpr_read_b32 v49, a5
    v_accvgpr_read_b32 v50, a6
    v_accvgpr_read_b32 v51, a7
    v_accvgpr_read_b32 v52, a20
    v_accvgpr_read_b32 v53, a21
    v_accvgpr_read_b32 v54, a22
    v_accvgpr_read_b32 v55, a23
    v_accvgpr_read_b32 v56, a36
    v_accvgpr_read_b32 v57, a37
    v_accvgpr_read_b32 v58, a38
    v_accvgpr_read_b32 v59, a39
    v_accvgpr_read_b32 v60, a52
    v_accvgpr_read_b32 v61, a53
    v_accvgpr_read_b32 v62, a54
    v_accvgpr_read_b32 v63, a55
Kb_next1:
    s_cmp_eq_u32 s3, 2
    s_cbranch_scc1 Kb_own2
    ds_write_b128 v3, a[8:11] offset:8192
    ds_write_b128 v3, a[24:27] offset:9216
    ds_write_b128 v3, a[40:43] offset:10240
    ds_write_b128 v3, a[56:59] offset:11264
    s_branch Kb_next2
Kb_own2:
    v_accvgpr_read_b32 v48, a8
    v_accvgpr_read_b32 v49, a9
    v_accvgpr_read_b32 v50, a10
    v_accvgpr_read_b32 v51, a11
    v_accvgpr_read_b32 v52, a24
    v_accvgpr_read_b32 v53, a25
    v_accvgpr_read_b32 v54, a26
    v_accvgpr_read_b32 v55, a27
    v_accvgpr_read_b32 v56, a40
    v_accvgpr_read_b32 v57, a41
    v_accvgpr_read_b32 v58, a42
    v_accvgpr_read_b32 v59, a43
    v_accvgpr_read_b32 v60, a56
    v_accvgpr_read_b32 v61, a57
    v_accvgpr_read_b32 v62, a58
    v_accvgpr_read_b32 v63, a59
Kb_next2:
    s_cmp_eq_u32 s3, 3
    s_cbranch_scc1 Kb_own3
    ds_write_b128 v3, a[12:15] offset:12288
    ds_write_b128 v3, a[28:31] offset:13312
    ds_write_b128 v3, a[44:47] offset:14336
    ds_write_b128 v3, a[60:63] offset:15360
    s_branch Kb_next3
Kb_own3:
    v_accvgpr_read_b32 v48, a12
    v_accvgpr_read_b32 v49, a13
    v_accvgpr_read_b32 v50, a14
    v_accvgpr_read_b32 v51, a15
    v_accvgpr_read_b32 v52, a28
    v_accvgpr_read_b32 v53, a29
    v_accvgpr_read_b32 v54, a30
    v_accvgpr_read_b32 v55, a31
    v_accvgpr_read_b32 v56, a44
    v_accvgpr_read_b32 v57, a45
    v_accvgpr_read_b32 v58, a46
    v_accvgpr_read_b32 v59, a47
    v_accvgpr_read_b32 v60, a60
    v_accvgpr_read_b32 v61, a61
    v_accvgpr_read_b32 v62, a62
    v_accvgpr_read_b32 v63, a63
Kb_next3:
    v_lshrrev_b32 v30, 4, v1
    v_bfe_u32 v5, v1, 2, 1
    v_lshlrev_b32 v5, 14, v5
    v_lshl_add_u32 v5, v30, 8, v5
    v_bfe_u32 v6, v1, 3, 1
    v_lshl_add_u32 v5, v6, 6, v5
    v_and_b32 v6, 3, v1
    v_lshl_add_u32 v5, v6, 4, v5
    s_and_b32 s13, s3, 1
    s_lshl_b32 s13, s13, 7
    v_add_u32 v5, s13, v5
    s_lshl_b32 s13, s7, 1
    s_lshr_b32 s14, s3, 1
    s_add_u32 s13, s13, s14
    s_lshl_b32 s13, s13, 15
    s_lshl_b32 s14, s6, 11
    s_add_u32 s13, s13, s14
    s_add_u32 s52, s32, 0x200000
    s_addc_u32 s53, s33, 0
    s_and_b32 s53, s53, 0xffff
    s_mov_b32 s54, 0x158000
    s_mov_b32 s55, 0x20000
    s_lshl_b32 s10, s7, 7
    s_lshl_b32 s11, s6, 2
    s_add_u32 s10, s10, s11
    s_waitcnt lgkmcnt(0)
    s_barrier
    ds_read_b128 v[64:67], v9 offset:0
    ds_read_b128 v[68:71], v9 offset:1024
    ds_read_b128 v[72:75], v9 offset:2048
    ds_read_b128 v[76:79], v9 offset:3072
    ds_read_b128 v[80:83], v10 offset:0
    ds_read_b128 v[84:87], v10 offset:1024
    ds_read_b128 v[88:91], v10 offset:2048
    ds_read_b128 v[92:95], v10 offset:3072
    ds_read_b128 v[96:99], v11 offset:0
    ds_read_b128 v[100:103], v11 offset:1024
    ds_read_b128 v[104:107], v11 offset:2048
    ds_read_b128 v[108:111], v11 offset:3072
    s_waitcnt lgkmcnt(8)
    v_add_f32 v48, v48, v64
    v_add_f32 v49, v49, v65
    v_add_f32 v50, v50, v66
    v_add_f32 v51, v51, v67
    v_add_f32 v52, v52, v68
    v_add_f32 v53, v53, v69
    v_add_f32 v54, v54, v70
    v_add_f32 v55, v55, v71
    v_add_f32 v56, v56, v72
    v_add_f32 v57, v57, v73
    v_add_f32 v58, v58, v74
    v_add_f32 v59, v59, v75
    v_add_f32 v60, v60, v76
    v_add_f32 v61, v61, v77
    v_add_f32 v62, v62, v78
    v_add_f32 v63, v63, v79
    s_waitcnt lgkmcnt(0)
    v_add_f32 v80, v80, v96
    v_add_f32 v81, v81, v97
    v_add_f32 v82, v82, v98
    v_add_f32 v83, v83, v99
    v_add_f32 v84, v84, v100
    v_add_f32 v85, v85, v101
    v_add_f32 v86, v86, v102
    v_add_f32 v87, v87, v103
    v_add_f32 v88, v88, v104
    v_add_f32 v89, v89, v105
    v_add_f32 v90, v90, v106
    v_add_f32 v91, v91, v107
    v_add_f32 v92, v92, v108
    v_add_f32 v93, v93, v109
    v_add_f32 v94, v94, v110
    v_add_f32 v95, v95, v111
    v_add_f32 v48, v48, v80
    v_add_f32 v49, v49, v81
    v_add_f32 v50, v50, v82
    v_add_f32 v51, v51, v83
    v_add_f32 v52, v52, v84
    v_add_f32 v53, v53, v85
    v_add_f32 v54, v54, v86
    v_add_f32 v55, v55, v87
    v_cvt_pk_bf16_f32 v112, v48, v49
    v_cvt_pk_bf16_f32 v113, v50, v51
    v_cvt_pk_bf16_f32 v114, v52, v53
    v_cvt_pk_bf16_f32 v115, v54, v55
    buffer_store_dwordx4 v[112:115], v5, s[52:55], s13 offen offset:0 sc1
    v_add_f32 v56, v56, v88
    v_add_f32 v57, v57, v89
    v_add_f32 v58, v58, v90
    v_add_f32 v59, v59, v91
    v_add_f32 v60, v60, v92
    v_add_f32 v61, v61, v93
    v_add_f32 v62, v62, v94
    v_add_f32 v63, v63, v95
    v_cvt_pk_bf16_f32 v116, v56, v57
    v_cvt_pk_bf16_f32 v117, v58, v59
    v_cvt_pk_bf16_f32 v118, v60, v61
    v_cvt_pk_bf16_f32 v119, v62, v63
    buffer_store_dwordx4 v[116:119], v5, s[52:55], s13 offen offset:1024 sc1
    s_waitcnt vmcnt(0)
    s_barrier
    s_cmp_lg_u32 s3, 0
    s_cbranch_scc1 PH2
    v_mov_b32 v2, s10
    v_mov_b32 v3, s19
    s_mov_b64 exec, 1
    buffer_store_dword v3, v2, s[20:23], 0 offen sc1
    s_mov_b64 exec, -1
    s_branch PH2
K_a:
    s_sub_u32 s5, s5, s9
    s_lshr_b32 s6, s4, 1
    s_and_b32 s7, s6, 1
    s_lshl_b32 s6, s6, 2
    s_sub_u32 s6, s6, s7
    s_lshr_b32 s7, s5, 1
    s_add_u32 s6, s6, s7
    s_and_b32 s7, s4, 1
    s_lshl_b32 s7, s7, 1
    s_and_b32 s8, s5, 1
    s_add_u32 s7, s7, s8
    s_lshl_b32 s8, s6, 7
    s_lshl_b32 s9, s3, 5
    s_add_u32 s8, s8, s9
    v_add_u32 v33, s8, v28
    v_lshlrev_b32 v33, 10, v33
    v_xor_b32 v34, v29, v30
    v_lshl_add_u32 v2, v34, 4, v33
    v_xor_b32 v3, 64, v2
    v_lshrrev_b32 v33, 1, v31
    v_xor_b32 v33, v33, v30
    v_and_b32 v34, 1, v1
    v_lshl_or_b32 v35, v33, 1, v34
    v_lshlrev_b32 v35, 4, v35
    v_lshl_add_u32 v35, v30, 10, v35
    s_lshl_b32 s8, s7, 8
    v_add_u32 v4, s8, v35
    v_xor_b32 v5, 128, v4
    s_lshl_b32 s56, s3, 12
    s_lshl_b32 s57, s3, 14
    s_lshl_b32 s61, s7, 1
    s_add_u32 s61, s61, s6
    s_and_b32 s61, s61, 7
    s_mov_b32 s36, s16
    s_and_b32 s37, s17, 0xffff
    s_mov_b32 s38, 0x200000
    s_mov_b32 s39, 0x20000
    s_mov_b32 s40, s24
    s_and_b32 s41, s25, 0xffff
    s_mov_b32 s42, 0x80000
    s_mov_b32 s43, 0x20000
    s_lshl_b32 s62, s61, 7
    s_lshl_b32 s63, s61, 16
    s_add_u32 s63, s63, s57
    s_add_u32 m0, s56, 0
    s_mov_b32 s58, s62
    buffer_load_dwordx4 v2, s[36:39], s58 offen lds
    s_add_u32 s58, s62, 7168
    buffer_load_dwordx4 v3, s[36:39], s58 offen offset:1024 lds
    s_add_u32 s58, s62, 14336
    buffer_load_dwordx4 v2, s[36:39], s58 offen offset:2048 lds
    s_add_u32 s58, s62, 21504
    buffer_load_dwordx4 v3, s[36:39], s58 offen offset:3072 lds
    s_add_u32 m0, s56, 16384
    s_add_u32 s58, s63, 0
    buffer_load_dwordx4 v4, s[40:43], s58 offen offset:0 lds
    s_add_u32 s58, s63, 3072
    buffer_load_dwordx4 v4, s[40:43], s58 offen offset:1024 lds
    s_add_u32 s58, s63, 6144
    buffer_load_dwordx4 v5, s[40:43], s58 offen offset:2048 lds
    s_add_u32 s58, s63, 9216
    buffer_load_dwordx4 v5, s[40:43], s58 offen offset:3072 lds
    s_add_u32 s61, s61, 1
    s_and_b32 s61, s61, 7
    s_lshl_b32 s62, s61, 7
    s_lshl_b32 s63, s61, 16
    s_add_u32 s63, s63, s57
    s_add_u32 m0, s56, 32768
    s_mov_b32 s58, s62
    buffer_load_dwordx4 v2, s[36:39], s58 offen lds
    s_add_u32 s58, s62, 7168
    buffer_load_dwordx4 v3, s[36:39], s58 offen offset:1024 lds
    s_add_u32 s58, s62, 14336
    buffer_load_dwordx4 v2, s[36:39], s58 offen offset:2048 lds
    s_add_u32 s58, s62, 21504
    buffer_load_dwordx4 v3, s[36:39], s58 offen offset:3072 lds
    s_add_u32 m0, s56, 49152
    s_add_u32 s58, s63, 0
    buffer_load_dwordx4 v4, s[40:43], s58 offen offset:0 lds
    s_add_u32 s58, s63, 3072
    buffer_load_dwordx4 v4, s[40:43], s58 offen offset:1024 lds
    s_add_u32 s58, s63, 6144
    buffer_load_dwordx4 v5, s[40:43], s58 offen offset:2048 lds
    s_add_u32 s58, s63, 9216
    buffer_load_dwordx4 v5, s[40:43], s58 offen offset:3072 lds
    s_add_u32 s61, s61, 1
    s_and_b32 s61, s61, 7
    s_lshl_b32 s62, s61, 7
    s_lshl_b32 s63, s61, 16
    s_add_u32 s63, s63, s57
    s_add_u32 m0, s56, 65536
    s_mov_b32 s58, s62
    buffer_load_dwordx4 v2, s[36:39], s58 offen lds
    s_add_u32 s58, s62, 7168
    buffer_load_dwordx4 v3, s[36:39], s58 offen offset:1024 lds
    s_add_u32 s58, s62, 14336
    buffer_load_dwordx4 v2, s[36:39], s58 offen offset:2048 lds
    s_add_u32 s58, s62, 21504
    buffer_load_dwordx4 v3, s[36:39], s58 offen offset:3072 lds
    s_add_u32 m0, s56, 81920
    s_add_u32 s58, s63, 0
    buffer_load_dwordx4 v4, s[40:43], s58 offen offset:0 lds
    s_add_u32 s58, s63, 3072
    buffer_load_dwordx4 v4, s[40:43], s58 offen offset:1024 lds
    s_add_u32 s58, s63, 6144
    buffer_load_dwordx4 v5, s[40:43], s58 offen offset:2048 lds
    s_add_u32 s58, s63, 9216
    buffer_load_dwordx4 v5, s[40:43], s58 offen offset:3072 lds
    s_add_u32 s61, s61, 1
    s_and_b32 s61, s61, 7
    s_add_u32 s44, s32, 0x0
    s_addc_u32 s45, s33, 0
    s_and_b32 s45, s45, 0xffff
    s_mov_b32 s46, 0x200000
    s_mov_b32 s47, 0x20000
    s_and_b32 s10, s3, 1
    s_lshr_b32 s11, s3, 1
    s_lshl_b32 s12, s11, 13
    v_lshrrev_b32 v33, 1, v31
    v_xor_b32 v33, v33, v30
    v_lshlrev_b32 v33, 4, v33
    v_lshl_add_u32 v33, v31, 7, v33
    v_add_u32 v6, s12, v33
    v_xor_b32 v7, 64, v6
    v_add_u32 v8, 0x10000, v6
    v_add_u32 v9, 0x10000, v7
    v_bfe_u32 v33, v1, 2, 2
    v_and_b32 v34, 3, v1
    v_lshl_add_u32 v35, v30, 3, v33
    v_lshlrev_b32 v35, 8, v35
    v_and_b32 v36, 1, v30
    v_lshl_add_u32 v36, v36, 2, v33
    v_lshl_add_u32 v35, v36, 5, v35
    v_lshl_add_u32 v35, v34, 3, v35
    s_lshl_b32 s12, s10, 7
    v_xor_b32 v35, s12, v35
    v_add_u32 v10, 16384, v35
    v_xor_b32 v11, 32, v10
    v_xor_b32 v12, 64, v10
    v_xor_b32 v13, 96, v10
    v_add_u32 v14, 0x10000, v10
    v_add_u32 v15, 0x10000, v11
    v_add_u32 v16, 0x10000, v12
    v_add_u32 v17, 0x10000, v13
    s_waitcnt vmcnt(16)
    s_barrier
    ds_read_b64_tr_b16 v[32:33], v10 offset:0
    ds_read_b64_tr_b16 v[34:35], v10 offset:1024
    ds_read_b64_tr_b16 v[36:37], v11 offset:0
    ds_read_b64_tr_b16 v[38:39], v11 offset:1024
    ds_read_b64_tr_b16 v[40:41], v12 offset:0
    ds_read_b64_tr_b16 v[42:43], v12 offset:1024
    ds_read_b64_tr_b16 v[44:45], v13 offset:0
    ds_read_b64_tr_b16 v[46:47], v13 offset:1024
    ds_read_b128 v[64:67], v6 offset:0
    ds_read_b128 v[68:71], v6 offset:2048
    ds_read_b128 v[72:75], v6 offset:4096
    ds_read_b128 v[76:79], v6 offset:6144
    s_waitcnt lgkmcnt(0)
    v_mfma_f32_16x16x32_bf16 v[144:147], v[32:35], v[64:67], 0
    ds_read_b64_tr_b16 v[48:49], v10 offset:8192
    ds_read_b64_tr_b16 v[50:51], v10 offset:9216
    v_mfma_f32_16x16x32_bf16 v[148:151], v[32:35], v[68:71], 0
    ds_read_b64_tr_b16 v[52:53], v11 offset:8192
    ds_read_b64_tr_b16 v[54:55], v11 offset:9216
    v_mfma_f32_16x16x32_bf16 v[152:155], v[32:35], v[72:75], 0
    ds_read_b64_tr_b16 v[56:57], v12 offset:8192
    ds_read_b64_tr_b16 v[58:59], v12 offset:9216
    v_mfma_f32_16x16x32_bf16 v[156:159], v[32:35], v[76:79], 0
    ds_read_b64_tr_b16 v[60:61], v13 offset:8192
    ds_read_b64_tr_b16 v[62:63], v13 offset:9216
    v_mfma_f32_16x16x32_bf16 v[160:163], v[36:39], v[64:67], 0
    ds_read_b128 v[80:83], v7 offset:0
    v_mfma_f32_16x16x32_bf16 v[164:167], v[36:39], v[68:71], 0
    ds_read_b128 v[84:87], v7 offset:2048
    v_mfma_f32_16x16x32_bf16 v[168:171], v[36:39], v[72:75], 0
    ds_read_b128 v[88:91], v7 offset:4096
    v_mfma_f32_16x16x32_bf16 v[172:175], v[36:39], v[76:79], 0
    ds_read_b128 v[92:95], v7 offset:6144
    v_mfma_f32_16x16x32_bf16 v[176:179], v[40:43], v[64:67], 0
    s_lshl_b32 s62, s61, 7
    s_lshl_b32 s63, s61, 16
    s_add_u32 s63, s63, s57
    s_add_u32 m0, s56, 98304
    s_mov_b32 s58, s62
    buffer_load_dwordx4 v2, s[36:39], s58 offen lds
    v_mfma_f32_16x16x32_bf16 v[180:183], v[40:43], v[68:71], 0
    s_add_u32 s58, s62, 7168
    buffer_load_dwordx4 v3, s[36:39], s58 offen offset:1024 lds
    v_mfma_f32_16x16x32_bf16 v[184:187], v[40:43], v[72:75], 0
    s_add_u32 s58, s62, 14336
    buffer_load_dwordx4 v2, s[36:39], s58 offen offset:2048 lds
    v_mfma_f32_16x16x32_bf16 v[188:191], v[40:43], v[76:79], 0
    s_add_u32 s58, s62, 21504
    buffer_load_dwordx4 v3, s[36:39], s58 offen offset:3072 lds
    v_mfma_f32_16x16x32_bf16 v[192:195], v[44:47], v[64:67], 0
    s_add_u32 m0, s56, 114688
    s_add_u32 s58, s63, 0
    buffer_load_dwordx4 v4, s[40:43], s58 offen offset:0 lds
    v_mfma_f32_16x16x32_bf16 v[196:199], v[44:47], v[68:71], 0
    s_add_u32 s58, s63, 3072
    buffer_load_dwordx4 v4, s[40:43], s58 offen offset:1024 lds
    v_mfma_f32_16x16x32_bf16 v[200:203], v[44:47], v[72:75], 0
    s_add_u32 s58, s63, 6144
    buffer_load_dwordx4 v5, s[40:43], s58 offen offset:2048 lds
    v_mfma_f32_16x16x32_bf16 v[204:207], v[44:47], v[76:79], 0
    s_add_u32 s58, s63, 9216
    buffer_load_dwordx4 v5, s[40:43], s58 offen offset:3072 lds
    s_add_u32 s61, s61, 1
    s_and_b32 s61, s61, 7
    s_waitcnt lgkmcnt(0)
    s_waitcnt vmcnt(16)
    s_barrier
    v_mfma_f32_16x16x32_bf16 v[144:147], v[48:51], v[80:83], v[144:147]
    ds_read_b64_tr_b16 v[32:33], v10 offset:32768
    ds_read_b64_tr_b16 v[34:35], v10 offset:33792
    v_mfma_f32_16x16x32_bf16 v[148:151], v[48:51], v[84:87], v[148:151]
    ds_read_b64_tr_b16 v[36:37], v11 offset:32768
    ds_read_b64_tr_b16 v[38:39], v11 offset:33792
    v_mfma_f32_16x16x32_bf16 v[152:155], v[48:51], v[88:91], v[152:155]
    ds_read_b64_tr_b16 v[40:41], v12 offset:32768
    ds_read_b64_tr_b16 v[42:43], v12 offset:33792
    v_mfma_f32_16x16x32_bf16 v[156:159], v[48:51], v[92:95], v[156:159]
    ds_read_b64_tr_b16 v[44:45], v13 offset:32768
    ds_read_b64_tr_b16 v[46:47], v13 offset:33792
    v_mfma_f32_16x16x32_bf16 v[160:163], v[52:55], v[80:83], v[160:163]
    ds_read_b128 v[64:67], v6 offset:32768
    v_mfma_f32_16x16x32_bf16 v[164:167], v[52:55], v[84:87], v[164:167]
    ds_read_b128 v[68:71], v6 offset:34816
    v_mfma_f32_16x16x32_bf16 v[168:171], v[52:55], v[88:91], v[168:171]
    ds_read_b128 v[72:75], v6 offset:36864
    v_mfma_f32_16x16x32_bf16 v[172:175], v[52:55], v[92:95], v[172:175]
    ds_read_b128 v[76:79], v6 offset:38912
    v_mfma_f32_16x16x32_bf16 v[176:179], v[56:59], v[80:83], v[176:179]
    s_lshl_b32 s62, s61, 7
    s_lshl_b32 s63, s61, 16
    s_add_u32 s63, s63, s57
    s_add_u32 m0, s56, 0
    s_mov_b32 s58, s62
    buffer_load_dwordx4 v2, s[36:39], s58 offen lds
    v_mfma_f32_16x16x32_bf16 v[180:183], v[56:59], v[84:87], v[180:183]
    s_add_u32 s58, s62, 7168
    buffer_load_dwordx4 v3, s[36:39], s58 offen offset:1024 lds
    v_mfma_f32_16x16x32_bf16 v[184:187], v[56:59], v[88:91], v[184:187]
    s_add_u32 s58, s62, 14336
    buffer_load_dwordx4 v2, s[36:39], s58 offen offset:2048 lds
    v_mfma_f32_16x16x32_bf16 v[188:191], v[56:59], v[92:95], v[188:191]
    s_add_u32 s58, s62, 21504
    buffer_load_dwordx4 v3, s[36:39], s58 offen offset:3072 lds
    v_mfma_f32_16x16x32_bf16 v[192:195], v[60:63], v[80:83], v[192:195]
    s_add_u32 m0, s56, 16384
    s_add_u32 s58, s63, 0
    buffer_load_dwordx4 v4, s[40:43], s58 offen offset:0 lds
    v_mfma_f32_16x16x32_bf16 v[196:199], v[60:63], v[84:87], v[196:199]
    s_add_u32 s58, s63, 3072
    buffer_load_dwordx4 v4, s[40:43], s58 offen offset:1024 lds
    v_mfma_f32_16x16x32_bf16 v[200:203], v[60:63], v[88:91], v[200:203]
    s_add_u32 s58, s63, 6144
    buffer_load_dwordx4 v5, s[40:43], s58 offen offset:2048 lds
    v_mfma_f32_16x16x32_bf16 v[204:207], v[60:63], v[92:95], v[204:207]
    s_add_u32 s58, s63, 9216
    buffer_load_dwordx4 v5, s[40:43], s58 offen offset:3072 lds
    s_add_u32 s61, s61, 1
    s_and_b32 s61, s61, 7
    s_waitcnt lgkmcnt(0)
    v_mfma_f32_16x16x32_bf16 v[144:147], v[32:35], v[64:67], v[144:147]
    v_mfma_f32_16x16x32_bf16 v[148:151], v[32:35], v[68:71], v[148:151]
    ds_read_b64_tr_b16 v[48:49], v10 offset:40960
    ds_read_b64_tr_b16 v[50:51], v10 offset:41984
    v_mfma_f32_16x16x32_bf16 v[152:155], v[32:35], v[72:75], v[152:155]
    v_mfma_f32_16x16x32_bf16 v[156:159], v[32:35], v[76:79], v[156:159]
    ds_read_b64_tr_b16 v[52:53], v11 offset:40960
    ds_read_b64_tr_b16 v[54:55], v11 offset:41984
    v_mfma_f32_16x16x32_bf16 v[160:163], v[36:39], v[64:67], v[160:163]
    v_mfma_f32_16x16x32_bf16 v[164:167], v[36:39], v[68:71], v[164:167]
    ds_read_b64_tr_b16 v[56:57], v12 offset:40960
    ds_read_b64_tr_b16 v[58:59], v12 offset:41984
    v_mfma_f32_16x16x32_bf16 v[168:171], v[36:39], v[72:75], v[168:171]
    v_mfma_f32_16x16x32_bf16 v[172:175], v[36:39], v[76:79], v[172:175]
    ds_read_b64_tr_b16 v[60:61], v13 offset:40960
    ds_read_b64_tr_b16 v[62:63], v13 offset:41984
    v_mfma_f32_16x16x32_bf16 v[176:179], v[40:43], v[64:67], v[176:179]
    v_mfma_f32_16x16x32_bf16 v[180:183], v[40:43], v[68:71], v[180:183]
    ds_read_b128 v[80:83], v7 offset:32768
    v_mfma_f32_16x16x32_bf16 v[184:187], v[40:43], v[72:75], v[184:187]
    v_mfma_f32_16x16x32_bf16 v[188:191], v[40:43], v[76:79], v[188:191]
    ds_read_b128 v[84:87], v7 offset:34816
    v_mfma_f32_16x16x32_bf16 v[192:195], v[44:47], v[64:67], v[192:195]
    v_mfma_f32_16x16x32_bf16 v[196:199], v[44:47], v[68:71], v[196:199]
    ds_read_b128 v[88:91], v7 offset:36864
    v_mfma_f32_16x16x32_bf16 v[200:203], v[44:47], v[72:75], v[200:203]
    v_mfma_f32_16x16x32_bf16 v[204:207], v[44:47], v[76:79], v[204:207]
    ds_read_b128 v[92:95], v7 offset:38912
    s_waitcnt lgkmcnt(0)
    s_waitcnt vmcnt(16)
    s_barrier
    v_mfma_f32_16x16x32_bf16 v[144:147], v[48:51], v[80:83], v[144:147]
    ds_read_b64_tr_b16 v[32:33], v14 offset:0
    ds_read_b64_tr_b16 v[34:35], v14 offset:1024
    v_mfma_f32_16x16x32_bf16 v[148:151], v[48:51], v[84:87], v[148:151]
    ds_read_b64_tr_b16 v[36:37], v15 offset:0
    ds_read_b64_tr_b16 v[38:39], v15 offset:1024
    v_mfma_f32_16x16x32_bf16 v[152:155], v[48:51], v[88:91], v[152:155]
    ds_read_b64_tr_b16 v[40:41], v16 offset:0
    ds_read_b64_tr_b16 v[42:43], v16 offset:1024
    v_mfma_f32_16x16x32_bf16 v[156:159], v[48:51], v[92:95], v[156:159]
    ds_read_b64_tr_b16 v[44:45], v17 offset:0
    ds_read_b64_tr_b16 v[46:47], v17 offset:1024
    v_mfma_f32_16x16x32_bf16 v[160:163], v[52:55], v[80:83], v[160:163]
    ds_read_b128 v[64:67], v8 offset:0
    v_mfma_f32_16x16x32_bf16 v[164:167], v[52:55], v[84:87], v[164:167]
    ds_read_b128 v[68:71], v8 offset:2048
    v_mfma_f32_16x16x32_bf16 v[168:171], v[52:55], v[88:91], v[168:171]
    ds_read_b128 v[72:75], v8 offset:4096
    v_mfma_f32_16x16x32_bf16 v[172:175], v[52:55], v[92:95], v[172:175]
    ds_read_b128 v[76:79], v8 offset:6144
    v_mfma_f32_16x16x32_bf16 v[176:179], v[56:59], v[80:83], v[176:179]
    s_lshl_b32 s62, s61, 7
    s_lshl_b32 s63, s61, 16
    s_add_u32 s63, s63, s57
    s_add_u32 m0, s56, 32768
    s_mov_b32 s58, s62
    buffer_load_dwordx4 v2, s[36:39], s58 offen lds
    v_mfma_f32_16x16x32_bf16 v[180:183], v[56:59], v[84:87], v[180:183]
    s_add_u32 s58, s62, 7168
    buffer_load_dwordx4 v3, s[36:39], s58 offen offset:1024 lds
    v_mfma_f32_16x16x32_bf16 v[184:187], v[56:59], v[88:91], v[184:187]
    s_add_u32 s58, s62, 14336
    buffer_load_dwordx4 v2, s[36:39], s58 offen offset:2048 lds
    v_mfma_f32_16x16x32_bf16 v[188:191], v[56:59], v[92:95], v[188:191]
    s_add_u32 s58, s62, 21504
    buffer_load_dwordx4 v3, s[36:39], s58 offen offset:3072 lds
    v_mfma_f32_16x16x32_bf16 v[192:195], v[60:63], v[80:83], v[192:195]
    s_add_u32 m0, s56, 49152
    s_add_u32 s58, s63, 0
    buffer_load_dwordx4 v4, s[40:43], s58 offen offset:0 lds
    v_mfma_f32_16x16x32_bf16 v[196:199], v[60:63], v[84:87], v[196:199]
    s_add_u32 s58, s63, 3072
    buffer_load_dwordx4 v4, s[40:43], s58 offen offset:1024 lds
    v_mfma_f32_16x16x32_bf16 v[200:203], v[60:63], v[88:91], v[200:203]
    s_add_u32 s58, s63, 6144
    buffer_load_dwordx4 v5, s[40:43], s58 offen offset:2048 lds
    v_mfma_f32_16x16x32_bf16 v[204:207], v[60:63], v[92:95], v[204:207]
    s_add_u32 s58, s63, 9216
    buffer_load_dwordx4 v5, s[40:43], s58 offen offset:3072 lds
    s_add_u32 s61, s61, 1
    s_and_b32 s61, s61, 7
    s_waitcnt lgkmcnt(0)
    v_mfma_f32_16x16x32_bf16 v[144:147], v[32:35], v[64:67], v[144:147]
    v_mfma_f32_16x16x32_bf16 v[148:151], v[32:35], v[68:71], v[148:151]
    ds_read_b64_tr_b16 v[48:49], v14 offset:8192
    ds_read_b64_tr_b16 v[50:51], v14 offset:9216
    v_mfma_f32_16x16x32_bf16 v[152:155], v[32:35], v[72:75], v[152:155]
    v_mfma_f32_16x16x32_bf16 v[156:159], v[32:35], v[76:79], v[156:159]
    ds_read_b64_tr_b16 v[52:53], v15 offset:8192
    ds_read_b64_tr_b16 v[54:55], v15 offset:9216
    v_mfma_f32_16x16x32_bf16 v[160:163], v[36:39], v[64:67], v[160:163]
    v_mfma_f32_16x16x32_bf16 v[164:167], v[36:39], v[68:71], v[164:167]
    ds_read_b64_tr_b16 v[56:57], v16 offset:8192
    ds_read_b64_tr_b16 v[58:59], v16 offset:9216
    v_mfma_f32_16x16x32_bf16 v[168:171], v[36:39], v[72:75], v[168:171]
    v_mfma_f32_16x16x32_bf16 v[172:175], v[36:39], v[76:79], v[172:175]
    ds_read_b64_tr_b16 v[60:61], v17 offset:8192
    ds_read_b64_tr_b16 v[62:63], v17 offset:9216
    v_mfma_f32_16x16x32_bf16 v[176:179], v[40:43], v[64:67], v[176:179]
    v_mfma_f32_16x16x32_bf16 v[180:183], v[40:43], v[68:71], v[180:183]
    ds_read_b128 v[80:83], v9 offset:0
    v_mfma_f32_16x16x32_bf16 v[184:187], v[40:43], v[72:75], v[184:187]
    v_mfma_f32_16x16x32_bf16 v[188:191], v[40:43], v[76:79], v[188:191]
    ds_read_b128 v[84:87], v9 offset:2048
    v_mfma_f32_16x16x32_bf16 v[192:195], v[44:47], v[64:67], v[192:195]
    v_mfma_f32_16x16x32_bf16 v[196:199], v[44:47], v[68:71], v[196:199]
    ds_read_b128 v[88:91], v9 offset:4096
    v_mfma_f32_16x16x32_bf16 v[200:203], v[44:47], v[72:75], v[200:203]
    v_mfma_f32_16x16x32_bf16 v[204:207], v[44:47], v[76:79], v[204:207]
    ds_read_b128 v[92:95], v9 offset:6144
    s_waitcnt lgkmcnt(0)
    s_waitcnt vmcnt(16)
    s_barrier
    v_mfma_f32_16x16x32_bf16 v[144:147], v[48:51], v[80:83], v[144:147]
    ds_read_b64_tr_b16 v[32:33], v14 offset:32768
    ds_read_b64_tr_b16 v[34:35], v14 offset:33792
    v_mfma_f32_16x16x32_bf16 v[148:151], v[48:51], v[84:87], v[148:151]
    ds_read_b64_tr_b16 v[36:37], v15 offset:32768
    ds_read_b64_tr_b16 v[38:39], v15 offset:33792
    v_mfma_f32_16x16x32_bf16 v[152:155], v[48:51], v[88:91], v[152:155]
    ds_read_b64_tr_b16 v[40:41], v16 offset:32768
    ds_read_b64_tr_b16 v[42:43], v16 offset:33792
    v_mfma_f32_16x16x32_bf16 v[156:159], v[48:51], v[92:95], v[156:159]
    ds_read_b64_tr_b16 v[44:45], v17 offset:32768
    ds_read_b64_tr_b16 v[46:47], v17 offset:33792
    v_mfma_f32_16x16x32_bf16 v[160:163], v[52:55], v[80:83], v[160:163]
    ds_read_b128 v[64:67], v8 offset:32768
    v_mfma_f32_16x16x32_bf16 v[164:167], v[52:55], v[84:87], v[164:167]
    ds_read_b128 v[68:71], v8 offset:34816
    v_mfma_f32_16x16x32_bf16 v[168:171], v[52:55], v[88:91], v[168:171]
    ds_read_b128 v[72:75], v8 offset:36864
    v_mfma_f32_16x16x32_bf16 v[172:175], v[52:55], v[92:95], v[172:175]
    ds_read_b128 v[76:79], v8 offset:38912
    v_mfma_f32_16x16x32_bf16 v[176:179], v[56:59], v[80:83], v[176:179]
    s_lshl_b32 s62, s61, 7
    s_lshl_b32 s63, s61, 16
    s_add_u32 s63, s63, s57
    s_add_u32 m0, s56, 65536
    s_mov_b32 s58, s62
    buffer_load_dwordx4 v2, s[36:39], s58 offen lds
    v_mfma_f32_16x16x32_bf16 v[180:183], v[56:59], v[84:87], v[180:183]
    s_add_u32 s58, s62, 7168
    buffer_load_dwordx4 v3, s[36:39], s58 offen offset:1024 lds
    v_mfma_f32_16x16x32_bf16 v[184:187], v[56:59], v[88:91], v[184:187]
    s_add_u32 s58, s62, 14336
    buffer_load_dwordx4 v2, s[36:39], s58 offen offset:2048 lds
    v_mfma_f32_16x16x32_bf16 v[188:191], v[56:59], v[92:95], v[188:191]
    s_add_u32 s58, s62, 21504
    buffer_load_dwordx4 v3, s[36:39], s58 offen offset:3072 lds
    v_mfma_f32_16x16x32_bf16 v[192:195], v[60:63], v[80:83], v[192:195]
    s_add_u32 m0, s56, 81920
    s_add_u32 s58, s63, 0
    buffer_load_dwordx4 v4, s[40:43], s58 offen offset:0 lds
    v_mfma_f32_16x16x32_bf16 v[196:199], v[60:63], v[84:87], v[196:199]
    s_add_u32 s58, s63, 3072
    buffer_load_dwordx4 v4, s[40:43], s58 offen offset:1024 lds
    v_mfma_f32_16x16x32_bf16 v[200:203], v[60:63], v[88:91], v[200:203]
    s_add_u32 s58, s63, 6144
    buffer_load_dwordx4 v5, s[40:43], s58 offen offset:2048 lds
    v_mfma_f32_16x16x32_bf16 v[204:207], v[60:63], v[92:95], v[204:207]
    s_add_u32 s58, s63, 9216
    buffer_load_dwordx4 v5, s[40:43], s58 offen offset:3072 lds
    s_add_u32 s61, s61, 1
    s_and_b32 s61, s61, 7
    s_waitcnt lgkmcnt(0)
    v_mfma_f32_16x16x32_bf16 v[144:147], v[32:35], v[64:67], v[144:147]
    v_mfma_f32_16x16x32_bf16 v[148:151], v[32:35], v[68:71], v[148:151]
    ds_read_b64_tr_b16 v[48:49], v14 offset:40960
    ds_read_b64_tr_b16 v[50:51], v14 offset:41984
    v_mfma_f32_16x16x32_bf16 v[152:155], v[32:35], v[72:75], v[152:155]
    v_mfma_f32_16x16x32_bf16 v[156:159], v[32:35], v[76:79], v[156:159]
    ds_read_b64_tr_b16 v[52:53], v15 offset:40960
    ds_read_b64_tr_b16 v[54:55], v15 offset:41984
    v_mfma_f32_16x16x32_bf16 v[160:163], v[36:39], v[64:67], v[160:163]
    v_mfma_f32_16x16x32_bf16 v[164:167], v[36:39], v[68:71], v[164:167]
    ds_read_b64_tr_b16 v[56:57], v16 offset:40960
    ds_read_b64_tr_b16 v[58:59], v16 offset:41984
    v_mfma_f32_16x16x32_bf16 v[168:171], v[36:39], v[72:75], v[168:171]
    v_mfma_f32_16x16x32_bf16 v[172:175], v[36:39], v[76:79], v[172:175]
    ds_read_b64_tr_b16 v[60:61], v17 offset:40960
    ds_read_b64_tr_b16 v[62:63], v17 offset:41984
    v_mfma_f32_16x16x32_bf16 v[176:179], v[40:43], v[64:67], v[176:179]
    v_mfma_f32_16x16x32_bf16 v[180:183], v[40:43], v[68:71], v[180:183]
    ds_read_b128 v[80:83], v9 offset:32768
    v_mfma_f32_16x16x32_bf16 v[184:187], v[40:43], v[72:75], v[184:187]
    v_mfma_f32_16x16x32_bf16 v[188:191], v[40:43], v[76:79], v[188:191]
    ds_read_b128 v[84:87], v9 offset:34816
    v_mfma_f32_16x16x32_bf16 v[192:195], v[44:47], v[64:67], v[192:195]
    v_mfma_f32_16x16x32_bf16 v[196:199], v[44:47], v[68:71], v[196:199]
    ds_read_b128 v[88:91], v9 offset:36864
    v_mfma_f32_16x16x32_bf16 v[200:203], v[44:47], v[72:75], v[200:203]
    v_mfma_f32_16x16x32_bf16 v[204:207], v[44:47], v[76:79], v[204:207]
    ds_read_b128 v[92:95], v9 offset:38912
    s_waitcnt lgkmcnt(0)
    s_waitcnt vmcnt(16)
    s_barrier
    v_mfma_f32_16x16x32_bf16 v[144:147], v[48:51], v[80:83], v[144:147]
    ds_read_b64_tr_b16 v[32:33], v10 offset:0
    ds_read_b64_tr_b16 v[34:35], v10 offset:1024
    v_mfma_f32_16x16x32_bf16 v[148:151], v[48:51], v[84:87], v[148:151]
    ds_read_b64_tr_b16 v[36:37], v11 offset:0
    ds_read_b64_tr_b16 v[38:39], v11 offset:1024
    v_mfma_f32_16x16x32_bf16 v[152:155], v[48:51], v[88:91], v[152:155]
    ds_read_b64_tr_b16 v[40:41], v12 offset:0
    ds_read_b64_tr_b16 v[42:43], v12 offset:1024
    v_mfma_f32_16x16x32_bf16 v[156:159], v[48:51], v[92:95], v[156:159]
    ds_read_b64_tr_b16 v[44:45], v13 offset:0
    ds_read_b64_tr_b16 v[46:47], v13 offset:1024
    v_mfma_f32_16x16x32_bf16 v[160:163], v[52:55], v[80:83], v[160:163]
    ds_read_b128 v[64:67], v6 offset:0
    v_mfma_f32_16x16x32_bf16 v[164:167], v[52:55], v[84:87], v[164:167]
    ds_read_b128 v[68:71], v6 offset:2048
    v_mfma_f32_16x16x32_bf16 v[168:171], v[52:55], v[88:91], v[168:171]
    ds_read_b128 v[72:75], v6 offset:4096
    v_mfma_f32_16x16x32_bf16 v[172:175], v[52:55], v[92:95], v[172:175]
    ds_read_b128 v[76:79], v6 offset:6144
    v_mfma_f32_16x16x32_bf16 v[176:179], v[56:59], v[80:83], v[176:179]
    s_lshl_b32 s62, s61, 7
    s_lshl_b32 s63, s61, 16
    s_add_u32 s63, s63, s57
    s_add_u32 m0, s56, 98304
    s_mov_b32 s58, s62
    buffer_load_dwordx4 v2, s[36:39], s58 offen lds
    v_mfma_f32_16x16x32_bf16 v[180:183], v[56:59], v[84:87], v[180:183]
    s_add_u32 s58, s62, 7168
    buffer_load_dwordx4 v3, s[36:39], s58 offen offset:1024 lds
    v_mfma_f32_16x16x32_bf16 v[184:187], v[56:59], v[88:91], v[184:187]
    s_add_u32 s58, s62, 14336
    buffer_load_dwordx4 v2, s[36:39], s58 offen offset:2048 lds
    v_mfma_f32_16x16x32_bf16 v[188:191], v[56:59], v[92:95], v[188:191]
    s_add_u32 s58, s62, 21504
    buffer_load_dwordx4 v3, s[36:39], s58 offen offset:3072 lds
    v_mfma_f32_16x16x32_bf16 v[192:195], v[60:63], v[80:83], v[192:195]
    s_add_u32 m0, s56, 114688
    s_add_u32 s58, s63, 0
    buffer_load_dwordx4 v4, s[40:43], s58 offen offset:0 lds
    v_mfma_f32_16x16x32_bf16 v[196:199], v[60:63], v[84:87], v[196:199]
    s_add_u32 s58, s63, 3072
    buffer_load_dwordx4 v4, s[40:43], s58 offen offset:1024 lds
    v_mfma_f32_16x16x32_bf16 v[200:203], v[60:63], v[88:91], v[200:203]
    s_add_u32 s58, s63, 6144
    buffer_load_dwordx4 v5, s[40:43], s58 offen offset:2048 lds
    v_mfma_f32_16x16x32_bf16 v[204:207], v[60:63], v[92:95], v[204:207]
    s_add_u32 s58, s63, 9216
    buffer_load_dwordx4 v5, s[40:43], s58 offen offset:3072 lds
    s_add_u32 s61, s61, 1
    s_and_b32 s61, s61, 7
    s_waitcnt lgkmcnt(0)
    v_mfma_f32_16x16x32_bf16 v[144:147], v[32:35], v[64:67], v[144:147]
    v_mfma_f32_16x16x32_bf16 v[148:151], v[32:35], v[68:71], v[148:151]
    ds_read_b64_tr_b16 v[48:49], v10 offset:8192
    ds_read_b64_tr_b16 v[50:51], v10 offset:9216
    v_mfma_f32_16x16x32_bf16 v[152:155], v[32:35], v[72:75], v[152:155]
    v_mfma_f32_16x16x32_bf16 v[156:159], v[32:35], v[76:79], v[156:159]
    ds_read_b64_tr_b16 v[52:53], v11 offset:8192
    ds_read_b64_tr_b16 v[54:55], v11 offset:9216
    v_mfma_f32_16x16x32_bf16 v[160:163], v[36:39], v[64:67], v[160:163]
    v_mfma_f32_16x16x32_bf16 v[164:167], v[36:39], v[68:71], v[164:167]
    ds_read_b64_tr_b16 v[56:57], v12 offset:8192
    ds_read_b64_tr_b16 v[58:59], v12 offset:9216
    v_mfma_f32_16x16x32_bf16 v[168:171], v[36:39], v[72:75], v[168:171]
    v_mfma_f32_16x16x32_bf16 v[172:175], v[36:39], v[76:79], v[172:175]
    ds_read_b64_tr_b16 v[60:61], v13 offset:8192
    ds_read_b64_tr_b16 v[62:63], v13 offset:9216
    v_mfma_f32_16x16x32_bf16 v[176:179], v[40:43], v[64:67], v[176:179]
    v_mfma_f32_16x16x32_bf16 v[180:183], v[40:43], v[68:71], v[180:183]
    ds_read_b128 v[80:83], v7 offset:0
    v_mfma_f32_16x16x32_bf16 v[184:187], v[40:43], v[72:75], v[184:187]
    v_mfma_f32_16x16x32_bf16 v[188:191], v[40:43], v[76:79], v[188:191]
    ds_read_b128 v[84:87], v7 offset:2048
    v_mfma_f32_16x16x32_bf16 v[192:195], v[44:47], v[64:67], v[192:195]
    v_mfma_f32_16x16x32_bf16 v[196:199], v[44:47], v[68:71], v[196:199]
    ds_read_b128 v[88:91], v7 offset:4096
    v_mfma_f32_16x16x32_bf16 v[200:203], v[44:47], v[72:75], v[200:203]
    v_mfma_f32_16x16x32_bf16 v[204:207], v[44:47], v[76:79], v[204:207]
    ds_read_b128 v[92:95], v7 offset:6144
    s_waitcnt lgkmcnt(0)
    s_waitcnt vmcnt(16)
    s_barrier
    v_mfma_f32_16x16x32_bf16 v[144:147], v[48:51], v[80:83], v[144:147]
    v_mfma_f32_16x16x32_bf16 v[148:151], v[48:51], v[84:87], v[148:151]
    ds_read_b64_tr_b16 v[32:33], v10 offset:32768
    ds_read_b64_tr_b16 v[34:35], v10 offset:33792
    v_mfma_f32_16x16x32_bf16 v[152:155], v[48:51], v[88:91], v[152:155]
    v_mfma_f32_16x16x32_bf16 v[156:159], v[48:51], v[92:95], v[156:159]
    ds_read_b64_tr_b16 v[36:37], v11 offset:32768
    ds_read_b64_tr_b16 v[38:39], v11 offset:33792
    v_mfma_f32_16x16x32_bf16 v[160:163], v[52:55], v[80:83], v[160:163]
    v_mfma_f32_16x16x32_bf16 v[164:167], v[52:55], v[84:87], v[164:167]
    ds_read_b64_tr_b16 v[40:41], v12 offset:32768
    ds_read_b64_tr_b16 v[42:43], v12 offset:33792
    v_mfma_f32_16x16x32_bf16 v[168:171], v[52:55], v[88:91], v[168:171]
    v_mfma_f32_16x16x32_bf16 v[172:175], v[52:55], v[92:95], v[172:175]
    ds_read_b64_tr_b16 v[44:45], v13 offset:32768
    ds_read_b64_tr_b16 v[46:47], v13 offset:33792
    v_mfma_f32_16x16x32_bf16 v[176:179], v[56:59], v[80:83], v[176:179]
    v_mfma_f32_16x16x32_bf16 v[180:183], v[56:59], v[84:87], v[180:183]
    ds_read_b128 v[64:67], v6 offset:32768
    v_mfma_f32_16x16x32_bf16 v[184:187], v[56:59], v[88:91], v[184:187]
    v_mfma_f32_16x16x32_bf16 v[188:191], v[56:59], v[92:95], v[188:191]
    ds_read_b128 v[68:71], v6 offset:34816
    v_mfma_f32_16x16x32_bf16 v[192:195], v[60:63], v[80:83], v[192:195]
    v_mfma_f32_16x16x32_bf16 v[196:199], v[60:63], v[84:87], v[196:199]
    ds_read_b128 v[72:75], v6 offset:36864
    v_mfma_f32_16x16x32_bf16 v[200:203], v[60:63], v[88:91], v[200:203]
    v_mfma_f32_16x16x32_bf16 v[204:207], v[60:63], v[92:95], v[204:207]
    ds_read_b128 v[76:79], v6 offset:38912
    s_waitcnt lgkmcnt(0)
    v_mfma_f32_16x16x32_bf16 v[144:147], v[32:35], v[64:67], v[144:147]
    v_mfma_f32_16x16x32_bf16 v[148:151], v[32:35], v[68:71], v[148:151]
    ds_read_b64_tr_b16 v[48:49], v10 offset:40960
    ds_read_b64_tr_b16 v[50:51], v10 offset:41984
    v_mfma_f32_16x16x32_bf16 v[152:155], v[32:35], v[72:75], v[152:155]
    v_mfma_f32_16x16x32_bf16 v[156:159], v[32:35], v[76:79], v[156:159]
    ds_read_b64_tr_b16 v[52:53], v11 offset:40960
    ds_read_b64_tr_b16 v[54:55], v11 offset:41984
    v_mfma_f32_16x16x32_bf16 v[160:163], v[36:39], v[64:67], v[160:163]
    v_mfma_f32_16x16x32_bf16 v[164:167], v[36:39], v[68:71], v[164:167]
    ds_read_b64_tr_b16 v[56:57], v12 offset:40960
    ds_read_b64_tr_b16 v[58:59], v12 offset:41984
    v_mfma_f32_16x16x32_bf16 v[168:171], v[36:39], v[72:75], v[168:171]
    v_mfma_f32_16x16x32_bf16 v[172:175], v[36:39], v[76:79], v[172:175]
    ds_read_b64_tr_b16 v[60:61], v13 offset:40960
    ds_read_b64_tr_b16 v[62:63], v13 offset:41984
    v_mfma_f32_16x16x32_bf16 v[176:179], v[40:43], v[64:67], v[176:179]
    v_mfma_f32_16x16x32_bf16 v[180:183], v[40:43], v[68:71], v[180:183]
    ds_read_b128 v[80:83], v7 offset:32768
    v_mfma_f32_16x16x32_bf16 v[184:187], v[40:43], v[72:75], v[184:187]
    v_mfma_f32_16x16x32_bf16 v[188:191], v[40:43], v[76:79], v[188:191]
    ds_read_b128 v[84:87], v7 offset:34816
    v_mfma_f32_16x16x32_bf16 v[192:195], v[44:47], v[64:67], v[192:195]
    v_mfma_f32_16x16x32_bf16 v[196:199], v[44:47], v[68:71], v[196:199]
    ds_read_b128 v[88:91], v7 offset:36864
    v_mfma_f32_16x16x32_bf16 v[200:203], v[44:47], v[72:75], v[200:203]
    v_mfma_f32_16x16x32_bf16 v[204:207], v[44:47], v[76:79], v[204:207]
    ds_read_b128 v[92:95], v7 offset:38912
    s_waitcnt lgkmcnt(0)
    s_waitcnt vmcnt(8)
    s_barrier
    v_mfma_f32_16x16x32_bf16 v[144:147], v[48:51], v[80:83], v[144:147]
    v_mfma_f32_16x16x32_bf16 v[148:151], v[48:51], v[84:87], v[148:151]
    ds_read_b64_tr_b16 v[32:33], v14 offset:0
    ds_read_b64_tr_b16 v[34:35], v14 offset:1024
    v_mfma_f32_16x16x32_bf16 v[152:155], v[48:51], v[88:91], v[152:155]
    v_mfma_f32_16x16x32_bf16 v[156:159], v[48:51], v[92:95], v[156:159]
    ds_read_b64_tr_b16 v[36:37], v15 offset:0
    ds_read_b64_tr_b16 v[38:39], v15 offset:1024
    v_mfma_f32_16x16x32_bf16 v[160:163], v[52:55], v[80:83], v[160:163]
    v_mfma_f32_16x16x32_bf16 v[164:167], v[52:55], v[84:87], v[164:167]
    ds_read_b64_tr_b16 v[40:41], v16 offset:0
    ds_read_b64_tr_b16 v[42:43], v16 offset:1024
    v_mfma_f32_16x16x32_bf16 v[168:171], v[52:55], v[88:91], v[168:171]
    v_mfma_f32_16x16x32_bf16 v[172:175], v[52:55], v[92:95], v[172:175]
    ds_read_b64_tr_b16 v[44:45], v17 offset:0
    ds_read_b64_tr_b16 v[46:47], v17 offset:1024
    v_mfma_f32_16x16x32_bf16 v[176:179], v[56:59], v[80:83], v[176:179]
    ds_read_b128 v[64:67], v8 offset:0
    v_mfma_f32_16x16x32_bf16 v[180:183], v[56:59], v[84:87], v[180:183]
    v_mfma_f32_16x16x32_bf16 v[184:187], v[56:59], v[88:91], v[184:187]
    ds_read_b128 v[68:71], v8 offset:2048
    v_mfma_f32_16x16x32_bf16 v[188:191], v[56:59], v[92:95], v[188:191]
    v_mfma_f32_16x16x32_bf16 v[192:195], v[60:63], v[80:83], v[192:195]
    ds_read_b128 v[72:75], v8 offset:4096
    v_mfma_f32_16x16x32_bf16 v[196:199], v[60:63], v[84:87], v[196:199]
    v_mfma_f32_16x16x32_bf16 v[200:203], v[60:63], v[88:91], v[200:203]
    ds_read_b128 v[76:79], v8 offset:6144
    v_mfma_f32_16x16x32_bf16 v[204:207], v[60:63], v[92:95], v[204:207]
    s_add_u32 s20, s32, 0x360000
    s_addc_u32 s21, s33, 0
    s_and_b32 s21, s21, 0xffff
    s_mov_b32 s22, 0x4000
    s_mov_b32 s23, 0x20000
    v_mov_b32 v211, 0
    buffer_load_dword v209, v211, s[92:95], 0 offen sc1
    s_add_u32 s8, s34, 32
    s_lshl_b32 s8, s8, 7
    v_and_b32 v212, 3, v1
    v_lshl_add_u32 v212, v212, 2, s8
    buffer_load_dword v210, v212, s[20:23], 0 offen sc1
    s_waitcnt lgkmcnt(0)
    v_mfma_f32_16x16x32_bf16 v[144:147], v[32:35], v[64:67], v[144:147]
    v_mfma_f32_16x16x32_bf16 v[148:151], v[32:35], v[68:71], v[148:151]
    ds_read_b64_tr_b16 v[48:49], v14 offset:8192
    ds_read_b64_tr_b16 v[50:51], v14 offset:9216
    v_mfma_f32_16x16x32_bf16 v[152:155], v[32:35], v[72:75], v[152:155]
    v_mfma_f32_16x16x32_bf16 v[156:159], v[32:35], v[76:79], v[156:159]
    ds_read_b64_tr_b16 v[52:53], v15 offset:8192
    ds_read_b64_tr_b16 v[54:55], v15 offset:9216
    v_mfma_f32_16x16x32_bf16 v[160:163], v[36:39], v[64:67], v[160:163]
    v_mfma_f32_16x16x32_bf16 v[164:167], v[36:39], v[68:71], v[164:167]
    ds_read_b64_tr_b16 v[56:57], v16 offset:8192
    ds_read_b64_tr_b16 v[58:59], v16 offset:9216
    v_mfma_f32_16x16x32_bf16 v[168:171], v[36:39], v[72:75], v[168:171]
    v_mfma_f32_16x16x32_bf16 v[172:175], v[36:39], v[76:79], v[172:175]
    ds_read_b64_tr_b16 v[60:61], v17 offset:8192
    ds_read_b64_tr_b16 v[62:63], v17 offset:9216
    v_mfma_f32_16x16x32_bf16 v[176:179], v[40:43], v[64:67], v[176:179]
    v_mfma_f32_16x16x32_bf16 v[180:183], v[40:43], v[68:71], v[180:183]
    ds_read_b128 v[80:83], v9 offset:0
    v_mfma_f32_16x16x32_bf16 v[184:187], v[40:43], v[72:75], v[184:187]
    v_mfma_f32_16x16x32_bf16 v[188:191], v[40:43], v[76:79], v[188:191]
    ds_read_b128 v[84:87], v9 offset:2048
    v_mfma_f32_16x16x32_bf16 v[192:195], v[44:47], v[64:67], v[192:195]
    v_mfma_f32_16x16x32_bf16 v[196:199], v[44:47], v[68:71], v[196:199]
    ds_read_b128 v[88:91], v9 offset:4096
    v_mfma_f32_16x16x32_bf16 v[200:203], v[44:47], v[72:75], v[200:203]
    v_mfma_f32_16x16x32_bf16 v[204:207], v[44:47], v[76:79], v[204:207]
    ds_read_b128 v[92:95], v9 offset:6144
    s_waitcnt lgkmcnt(0)
    s_waitcnt vmcnt(2)
    s_barrier
    v_mfma_f32_16x16x32_bf16 v[144:147], v[48:51], v[80:83], v[144:147]
    v_mfma_f32_16x16x32_bf16 v[148:151], v[48:51], v[84:87], v[148:151]
    ds_read_b64_tr_b16 v[32:33], v14 offset:32768
    ds_read_b64_tr_b16 v[34:35], v14 offset:33792
    v_mfma_f32_16x16x32_bf16 v[152:155], v[48:51], v[88:91], v[152:155]
    v_mfma_f32_16x16x32_bf16 v[156:159], v[48:51], v[92:95], v[156:159]
    ds_read_b64_tr_b16 v[36:37], v15 offset:32768
    ds_read_b64_tr_b16 v[38:39], v15 offset:33792
    v_mfma_f32_16x16x32_bf16 v[160:163], v[52:55], v[80:83], v[160:163]
    v_mfma_f32_16x16x32_bf16 v[164:167], v[52:55], v[84:87], v[164:167]
    ds_read_b64_tr_b16 v[40:41], v16 offset:32768
    ds_read_b64_tr_b16 v[42:43], v16 offset:33792
    v_mfma_f32_16x16x32_bf16 v[168:171], v[52:55], v[88:91], v[168:171]
    v_mfma_f32_16x16x32_bf16 v[172:175], v[52:55], v[92:95], v[172:175]
    ds_read_b64_tr_b16 v[44:45], v17 offset:32768
    ds_read_b64_tr_b16 v[46:47], v17 offset:33792
    v_mfma_f32_16x16x32_bf16 v[176:179], v[56:59], v[80:83], v[176:179]
    v_mfma_f32_16x16x32_bf16 v[180:183], v[56:59], v[84:87], v[180:183]
    ds_read_b128 v[64:67], v8 offset:32768
    v_mfma_f32_16x16x32_bf16 v[184:187], v[56:59], v[88:91], v[184:187]
    v_mfma_f32_16x16x32_bf16 v[188:191], v[56:59], v[92:95], v[188:191]
    ds_read_b128 v[68:71], v8 offset:34816
    v_mfma_f32_16x16x32_bf16 v[192:195], v[60:63], v[80:83], v[192:195]
    v_mfma_f32_16x16x32_bf16 v[196:199], v[60:63], v[84:87], v[196:199]
    ds_read_b128 v[72:75], v8 offset:36864
    v_mfma_f32_16x16x32_bf16 v[200:203], v[60:63], v[88:91], v[200:203]
    v_mfma_f32_16x16x32_bf16 v[204:207], v[60:63], v[92:95], v[204:207]
    ds_read_b128 v[76:79], v8 offset:38912
    s_waitcnt lgkmcnt(0)
    v_mfma_f32_16x16x32_bf16 v[144:147], v[32:35], v[64:67], v[144:147]
    v_mfma_f32_16x16x32_bf16 v[148:151], v[32:35], v[68:71], v[148:151]
    ds_read_b64_tr_b16 v[48:49], v14 offset:40960
    ds_read_b64_tr_b16 v[50:51], v14 offset:41984
    v_mfma_f32_16x16x32_bf16 v[152:155], v[32:35], v[72:75], v[152:155]
    v_mfma_f32_16x16x32_bf16 v[156:159], v[32:35], v[76:79], v[156:159]
    ds_read_b64_tr_b16 v[52:53], v15 offset:40960
    ds_read_b64_tr_b16 v[54:55], v15 offset:41984
    v_mfma_f32_16x16x32_bf16 v[160:163], v[36:39], v[64:67], v[160:163]
    v_mfma_f32_16x16x32_bf16 v[164:167], v[36:39], v[68:71], v[164:167]
    ds_read_b64_tr_b16 v[56:57], v16 offset:40960
    ds_read_b64_tr_b16 v[58:59], v16 offset:41984
    v_mfma_f32_16x16x32_bf16 v[168:171], v[36:39], v[72:75], v[168:171]
    v_mfma_f32_16x16x32_bf16 v[172:175], v[36:39], v[76:79], v[172:175]
    ds_read_b64_tr_b16 v[60:61], v17 offset:40960
    ds_read_b64_tr_b16 v[62:63], v17 offset:41984
    v_mfma_f32_16x16x32_bf16 v[176:179], v[40:43], v[64:67], v[176:179]
    v_mfma_f32_16x16x32_bf16 v[180:183], v[40:43], v[68:71], v[180:183]
    ds_read_b128 v[80:83], v9 offset:32768
    v_mfma_f32_16x16x32_bf16 v[184:187], v[40:43], v[72:75], v[184:187]
    v_mfma_f32_16x16x32_bf16 v[188:191], v[40:43], v[76:79], v[188:191]
    ds_read_b128 v[84:87], v9 offset:34816
    v_mfma_f32_16x16x32_bf16 v[192:195], v[44:47], v[64:67], v[192:195]
    v_mfma_f32_16x16x32_bf16 v[196:199], v[44:47], v[68:71], v[196:199]
    ds_read_b128 v[88:91], v9 offset:36864
    v_mfma_f32_16x16x32_bf16 v[200:203], v[44:47], v[72:75], v[200:203]
    v_mfma_f32_16x16x32_bf16 v[204:207], v[44:47], v[76:79], v[204:207]
    ds_read_b128 v[92:95], v9 offset:38912
    s_waitcnt lgkmcnt(0)
    v_mfma_f32_16x16x32_bf16 v[144:147], v[48:51], v[80:83], v[144:147]
    v_mfma_f32_16x16x32_bf16 v[148:151], v[48:51], v[84:87], v[148:151]
    v_mfma_f32_16x16x32_bf16 v[152:155], v[48:51], v[88:91], v[152:155]
    v_mfma_f32_16x16x32_bf16 v[156:159], v[48:51], v[92:95], v[156:159]
    v_mfma_f32_16x16x32_bf16 v[160:163], v[52:55], v[80:83], v[160:163]
    v_mfma_f32_16x16x32_bf16 v[164:167], v[52:55], v[84:87], v[164:167]
    v_mfma_f32_16x16x32_bf16 v[168:171], v[52:55], v[88:91], v[168:171]
    v_mfma_f32_16x16x32_bf16 v[172:175], v[52:55], v[92:95], v[172:175]
    v_mfma_f32_16x16x32_bf16 v[176:179], v[56:59], v[80:83], v[176:179]
    v_mfma_f32_16x16x32_bf16 v[180:183], v[56:59], v[84:87], v[180:183]
    v_mfma_f32_16x16x32_bf16 v[184:187], v[56:59], v[88:91], v[184:187]
    v_mfma_f32_16x16x32_bf16 v[188:191], v[56:59], v[92:95], v[188:191]
    v_mfma_f32_16x16x32_bf16 v[192:195], v[60:63], v[80:83], v[192:195]
    v_mfma_f32_16x16x32_bf16 v[196:199], v[60:63], v[84:87], v[196:199]
    v_mfma_f32_16x16x32_bf16 v[200:203], v[60:63], v[88:91], v[200:203]
    v_mfma_f32_16x16x32_bf16 v[204:207], v[60:63], v[92:95], v[204:207]
    v_lshlrev_b32 v2, 4, v1
    s_lshl_b32 s12, s6, 3
    s_lshl_b32 s13, s11, 2
    s_add_u32 s12, s12, s13
    s_lshl_b32 s12, s12, 4
    s_lshl_b32 s13, s7, 2
    s_add_u32 s12, s12, s13
    s_lshl_b32 s13, s10, 1
    s_add_u32 s12, s12, s13
    s_lshl_b32 s12, s12, 10
    s_add_u32 s14, s6, 32
    s_lshl_b32 s14, s14, 7
    s_lshl_b32 s15, s7, 2
    s_add_u32 s14, s14, s15
    s_add_u32 s13, s12, 0
    v_cvt_pk_bf16_f32 v32, v144, v145
    v_cvt_pk_bf16_f32 v33, v146, v147
    v_cvt_pk_bf16_f32 v34, v160, v161
    v_cvt_pk_bf16_f32 v35, v162, v163
    buffer_store_dwordx4 v[32:35], v2, s[44:47], s13 offen offset:0 sc1
    v_cvt_pk_bf16_f32 v36, v176, v177
    v_cvt_pk_bf16_f32 v37, v178, v179
    v_cvt_pk_bf16_f32 v38, v192, v193
    v_cvt_pk_bf16_f32 v39, v194, v195
    buffer_store_dwordx4 v[36:39], v2, s[44:47], s13 offen offset:1024 sc1
    s_add_u32 s13, s12, 16384
    v_cvt_pk_bf16_f32 v40, v148, v149
    v_cvt_pk_bf16_f32 v41, v150, v151
    v_cvt_pk_bf16_f32 v42, v164, v165
    v_cvt_pk_bf16_f32 v43, v166, v167
    buffer_store_dwordx4 v[40:43], v2, s[44:47], s13 offen offset:0 sc1
    v_cvt_pk_bf16_f32 v44, v180, v181
    v_cvt_pk_bf16_f32 v45, v182, v183
    v_cvt_pk_bf16_f32 v46, v196, v197
    v_cvt_pk_bf16_f32 v47, v198, v199
    buffer_store_dwordx4 v[44:47], v2, s[44:47], s13 offen offset:1024 sc1
    s_add_u32 s13, s12, 32768
    v_cvt_pk_bf16_f32 v32, v152, v153
    v_cvt_pk_bf16_f32 v33, v154, v155
    v_cvt_pk_bf16_f32 v34, v168, v169
    v_cvt_pk_bf16_f32 v35, v170, v171
    buffer_store_dwordx4 v[32:35], v2, s[44:47], s13 offen offset:0 sc1
    v_cvt_pk_bf16_f32 v36, v184, v185
    v_cvt_pk_bf16_f32 v37, v186, v187
    v_cvt_pk_bf16_f32 v38, v200, v201
    v_cvt_pk_bf16_f32 v39, v202, v203
    buffer_store_dwordx4 v[36:39], v2, s[44:47], s13 offen offset:1024 sc1
    s_add_u32 s13, s12, 49152
    v_cvt_pk_bf16_f32 v40, v156, v157
    v_cvt_pk_bf16_f32 v41, v158, v159
    v_cvt_pk_bf16_f32 v42, v172, v173
    v_cvt_pk_bf16_f32 v43, v174, v175
    buffer_store_dwordx4 v[40:43], v2, s[44:47], s13 offen offset:0 sc1
    v_cvt_pk_bf16_f32 v44, v188, v189
    v_cvt_pk_bf16_f32 v45, v190, v191
    v_cvt_pk_bf16_f32 v46, v204, v205
    v_cvt_pk_bf16_f32 v47, v206, v207
    buffer_store_dwordx4 v[44:47], v2, s[44:47], s13 offen offset:1024 sc1
    s_waitcnt vmcnt(0)
    s_mov_b32 s8, 0
FA_tl:
    v_readfirstlane_b32 s19, v209
    s_nop 3
    s_cmp_lg_u32 s19, 0
    s_cbranch_scc1 FA_td
    s_add_u32 s8, s8, 1
    s_cmp_ge_u32 s8, 0x10000
    s_cbranch_scc1 FA_td
    s_sleep 2
    buffer_load_dword v209, v211, s[92:95], 0 offen sc1
    s_waitcnt vmcnt(0)
    s_branch FA_tl
FA_td:
    s_waitcnt vmcnt(0)
    s_barrier
    s_cmp_lg_u32 s3, 0
    s_cbranch_scc1 PH2
    v_mov_b32 v2, s14
    v_mov_b32 v3, s19
    s_mov_b64 exec, 1
    buffer_store_dword v3, v2, s[20:23], 0 offen sc1
    s_mov_b64 exec, -1
    s_branch PH2
K_nop1:
    s_add_u32 s20, s32, 0x360000
    s_addc_u32 s21, s33, 0
    s_and_b32 s21, s21, 0xffff
    s_mov_b32 s22, 0x4000
    s_mov_b32 s23, 0x20000
    v_mov_b32 v211, 0
    buffer_load_dword v209, v211, s[92:95], 0 offen sc1
    s_add_u32 s8, s34, 32
    s_lshl_b32 s8, s8, 7
    v_and_b32 v212, 3, v1
    v_lshl_add_u32 v212, v212, 2, s8
    buffer_load_dword v210, v212, s[20:23], 0 offen sc1
    s_waitcnt vmcnt(0)
    s_mov_b32 s8, 0
NP_tl:
    v_readfirstlane_b32 s19, v209
    s_nop 3
    s_cmp_lg_u32 s19, 0
    s_cbranch_scc1 NP_td
    s_add_u32 s8, s8, 1
    s_cmp_ge_u32 s8, 0x10000
    s_cbranch_scc1 NP_td
    s_sleep 2
    buffer_load_dword v209, v211, s[92:95], 0 offen sc1
    s_waitcnt vmcnt(0)
    s_branch NP_tl
NP_td:
PH2:
    s_cmp_ge_u32 s35, 15
    s_cbranch_scc1 PH2_exit
    s_mov_b32 s8, 0
    s_branch PX_chk
PX_loop:
    buffer_load_dword v210, v212, s[20:23], 0 offen sc1
    s_waitcnt vmcnt(0)
PX_chk:
    v_cmp_ne_u32 vcc, s19, v210
    s_nop 4
    s_cbranch_vccz PX_done
    s_sleep 2
    s_add_u32 s8, s8, 1
    s_cmp_lt_u32 s8, 0x10000
    s_cbranch_scc1 PX_loop
PX_done:
    s_add_u32 s24, s32, 0x0
    s_addc_u32 s25, s33, 0
    s_and_b32 s25, s25, 0xffff
    s_mov_b32 s26, 0x200000
    s_mov_b32 s27, 0x20000
    v_lshlrev_b32 v213, 4, v1
    s_lshl_b32 s9, s34, 3
    s_lshl_b32 s10, s3, 1
    s_add_u32 s9, s9, s10
    s_lshl_b32 s63, s9, 14
    s_mul_i32 s16, s35, 96
    s_add_u32 s17, s16, 95
    s_lshr_b32 s16, s16, 6
    s_lshr_b32 s17, s17, 6
    s_min_u32 s17, s17, 21
    v_bfe_u32 v12, v1, 3, 2
    v_add_u32 v12, s16, v12
    v_min_u32 v12, s17, v12
    v_and_b32 v13, 7, v1
    v_lshlrev_b32 v13, 2, v13
    v_lshl_add_u32 v11, v12, 7, v13
    s_add_u32 s9, s63, 0
    buffer_load_dwordx4 a[64:67], v213, s[24:27], s9 offen offset:0
    buffer_load_dwordx4 a[68:71], v213, s[24:27], s9 offen offset:1024
    buffer_load_dwordx4 a[72:75], v213, s[24:27], s9 offen offset:2048
    buffer_load_dwordx4 a[76:79], v213, s[24:27], s9 offen offset:3072
    s_add_u32 s9, s63, 16384
    buffer_load_dwordx4 a[128:131], v213, s[24:27], s9 offen offset:0
    buffer_load_dwordx4 a[132:135], v213, s[24:27], s9 offen offset:1024
    buffer_load_dwordx4 a[136:139], v213, s[24:27], s9 offen offset:2048
    buffer_load_dwordx4 a[140:143], v213, s[24:27], s9 offen offset:3072
    s_add_u32 s9, s63, 4096
    buffer_load_dwordx4 a[80:83], v213, s[24:27], s9 offen offset:0
    buffer_load_dwordx4 a[84:87], v213, s[24:27], s9 offen offset:1024
    buffer_load_dwordx4 a[88:91], v213, s[24:27], s9 offen offset:2048
    buffer_load_dwordx4 a[92:95], v213, s[24:27], s9 offen offset:3072
    s_add_u32 s9, s63, 20480
    buffer_load_dwordx4 a[144:147], v213, s[24:27], s9 offen offset:0
    buffer_load_dwordx4 a[148:151], v213, s[24:27], s9 offen offset:1024
    buffer_load_dwordx4 a[152:155], v213, s[24:27], s9 offen offset:2048
    buffer_load_dwordx4 a[156:159], v213, s[24:27], s9 offen offset:3072
    s_add_u32 s9, s63, 8192
    buffer_load_dwordx4 a[96:99], v213, s[24:27], s9 offen offset:0
    buffer_load_dwordx4 a[100:103], v213, s[24:27], s9 offen offset:1024
    buffer_load_dwordx4 a[104:107], v213, s[24:27], s9 offen offset:2048
    buffer_load_dwordx4 a[108:111], v213, s[24:27], s9 offen offset:3072
    s_add_u32 s9, s63, 24576
    buffer_load_dwordx4 a[160:163], v213, s[24:27], s9 offen offset:0
    buffer_load_dwordx4 a[164:167], v213, s[24:27], s9 offen offset:1024
    buffer_load_dwordx4 a[168:171], v213, s[24:27], s9 offen offset:2048
    buffer_load_dwordx4 a[172:175], v213, s[24:27], s9 offen offset:3072
    s_add_u32 s9, s63, 12288
    buffer_load_dwordx4 a[112:115], v213, s[24:27], s9 offen offset:0
    buffer_load_dwordx4 a[116:119], v213, s[24:27], s9 offen offset:1024
    buffer_load_dwordx4 a[120:123], v213, s[24:27], s9 offen offset:2048
    buffer_load_dwordx4 a[124:127], v213, s[24:27], s9 offen offset:3072
    s_add_u32 s9, s63, 28672
    buffer_load_dwordx4 a[176:179], v213, s[24:27], s9 offen offset:0
    buffer_load_dwordx4 a[180:183], v213, s[24:27], s9 offen offset:1024
    buffer_load_dwordx4 a[184:187], v213, s[24:27], s9 offen offset:2048
    buffer_load_dwordx4 a[188:191], v213, s[24:27], s9 offen offset:3072
PH2B:
    s_add_u32 s40, s32, 0x200000
    s_addc_u32 s41, s33, 0
    s_and_b32 s41, s41, 0xffff
    s_mov_b32 s42, 0x158000
    s_mov_b32 s43, 0x20000
    s_mov_b32 s44, s28
    s_and_b32 s45, s29, 0xffff
    s_mov_b32 s46, 0x560000
    s_mov_b32 s47, 0x20000
    v_lshlrev_b32 v2, 4, v1
    v_add_u32 v10, 0x10000, v2
    s_mul_i32 s12, s35, 96
    s_add_u32 s12, s12, s3
    s_lshl_b32 s12, s12, 10
    s_mul_i32 s14, s3, 6144
    s_mul_i32 s15, s3, 2560
    s_add_u32 s15, s15, 98304
    v_and_b32 v13, 15, v1
    v_lshrrev_b32 v14, 4, v1
    v_mul_u32_u24 v3, 80, v13
    v_lshl_add_u32 v3, v14, 4, v3
    v_add_u32 v3, s15, v3
    v_lshrrev_b32 v13, 2, v1
    v_and_b32 v14, 3, v1
    v_mul_u32_u24 v4, 80, v13
    v_lshl_add_u32 v4, v14, 4, v4
    v_add_u32 v4, s15, v4
    s_lshl_b32 s16, s34, 7
    s_lshl_b32 s17, s3, 5
    s_add_u32 s16, s16, s17
    s_mul_i32 s16, s16, 2752
    s_mul_i32 s17, s35, 192
    s_add_u32 s16, s16, s17
    v_mul_u32_u24 v5, 2752, v13
    v_lshl_add_u32 v5, v14, 4, v5
    v_add_u32 v5, s16, v5
    v_add_u32 v6, 44032, v5
    s_mov_b32 s9, 0x7f000000
    s_add_u32 s8, s17, 64
    s_cmp_le_u32 s8, 2752
    s_cselect_b32 s52, 0, s9
    s_add_u32 s8, s17, 128
    s_cmp_le_u32 s8, 2752
    s_cselect_b32 s53, 64, s9
    s_add_u32 s8, s17, 192
    s_cmp_le_u32 s8, 2752
    s_cselect_b32 s54, 128, s9
    s_cmp_lg_u32 s3, 0
    s_cbranch_scc1 PP_done
    s_mov_b32 s8, 0
PP_loop:
    buffer_load_dword v15, v11, s[20:23], 0 offen sc1
    s_waitcnt vmcnt(0)
PP_chk:
    v_cmp_ne_u32 vcc, s19, v15
    s_nop 4
    s_cbranch_vccz PP_done
    s_sleep 1
    s_add_u32 s8, s8, 1
    s_cmp_lt_u32 s8, 0x10000
    s_cbranch_scc1 PP_loop
PP_done:
    s_barrier
    s_add_u32 m0, s14, 0
    s_add_u32 s58, s12, 0
    buffer_load_dwordx4 v2, s[40:43], s58 offen offset:0 lds
    s_add_u32 s58, s12, 15360
    buffer_load_dwordx4 v2, s[40:43], s58 offen offset:1024 lds
    s_add_u32 m0, s14, 24576
    s_add_u32 s58, s12, 4096
    buffer_load_dwordx4 v2, s[40:43], s58 offen offset:0 lds
    s_add_u32 s58, s12, 19456
    buffer_load_dwordx4 v2, s[40:43], s58 offen offset:1024 lds
    s_add_u32 m0, s14, 49152
    s_add_u32 s58, s12, 8192
    buffer_load_dwordx4 v2, s[40:43], s58 offen offset:0 lds
    s_add_u32 s58, s12, 23552
    buffer_load_dwordx4 v2, s[40:43], s58 offen offset:1024 lds
    s_add_u32 m0, s14, 73728
    s_add_u32 s58, s12, 12288
    buffer_load_dwordx4 v2, s[40:43], s58 offen offset:0 lds
    s_add_u32 s58, s12, 27648
    buffer_load_dwordx4 v2, s[40:43], s58 offen offset:1024 lds
    s_add_u32 m0, s14, 2048
    s_add_u32 s58, s12, 32768
    buffer_load_dwordx4 v2, s[40:43], s58 offen offset:0 lds
    s_add_u32 s58, s12, 48128
    buffer_load_dwordx4 v2, s[40:43], s58 offen offset:1024 lds
    s_add_u32 m0, s14, 26624
    s_add_u32 s58, s12, 36864
    buffer_load_dwordx4 v2, s[40:43], s58 offen offset:0 lds
    s_add_u32 s58, s12, 52224
    buffer_load_dwordx4 v2, s[40:43], s58 offen offset:1024 lds
    s_add_u32 m0, s14, 51200
    s_add_u32 s58, s12, 40960
    buffer_load_dwordx4 v2, s[40:43], s58 offen offset:0 lds
    s_add_u32 s58, s12, 56320
    buffer_load_dwordx4 v2, s[40:43], s58 offen offset:1024 lds
    s_add_u32 m0, s14, 75776
    s_add_u32 s58, s12, 45056
    buffer_load_dwordx4 v2, s[40:43], s58 offen offset:0 lds
    s_add_u32 s58, s12, 60416
    buffer_load_dwordx4 v2, s[40:43], s58 offen offset:1024 lds
    s_waitcnt vmcnt(12)
    s_barrier
    ds_read_b128 v[16:19], v2 offset:0
    ds_read_b128 v[20:23], v2 offset:1024
    ds_read_b128 v[24:27], v2 offset:6144
    ds_read_b128 v[28:31], v2 offset:7168
    ds_read_b128 v[32:35], v2 offset:12288
    ds_read_b128 v[36:39], v2 offset:13312
    ds_read_b128 v[40:43], v2 offset:18432
    ds_read_b128 v[44:47], v2 offset:19456
    s_waitcnt lgkmcnt(4)
    v_mfma_f32_16x16x32_bf16 v[192:195], v[16:19], a[64:67], 0
    ds_read_b128 v[64:67], v2 offset:24576
    v_mfma_f32_16x16x32_bf16 v[200:203], v[16:19], a[128:131], 0
    ds_read_b128 v[68:71], v2 offset:25600
    v_mfma_f32_16x16x32_bf16 v[196:199], v[20:23], a[64:67], 0
    ds_read_b128 v[72:75], v2 offset:30720
    v_mfma_f32_16x16x32_bf16 v[204:207], v[20:23], a[128:131], 0
    ds_read_b128 v[76:79], v2 offset:31744
    v_mfma_f32_16x16x32_bf16 v[192:195], v[24:27], a[68:71], v[192:195]
    s_add_u32 m0, s14, 4096
    s_add_u32 s58, s12, 65536
    buffer_load_dwordx4 v2, s[40:43], s58 offen offset:0 lds
    v_mfma_f32_16x16x32_bf16 v[200:203], v[24:27], a[132:135], v[200:203]
    s_add_u32 s58, s12, 80896
    buffer_load_dwordx4 v2, s[40:43], s58 offen offset:1024 lds
    v_mfma_f32_16x16x32_bf16 v[196:199], v[28:31], a[68:71], v[196:199]
    s_add_u32 m0, s14, 28672
    s_add_u32 s58, s12, 69632
    buffer_load_dwordx4 v2, s[40:43], s58 offen offset:0 lds
    v_mfma_f32_16x16x32_bf16 v[204:207], v[28:31], a[132:135], v[204:207]
    s_add_u32 s58, s12, 84992
    buffer_load_dwordx4 v2, s[40:43], s58 offen offset:1024 lds
    s_waitcnt lgkmcnt(4)
    v_mfma_f32_16x16x32_bf16 v[192:195], v[32:35], a[72:75], v[192:195]
    ds_read_b128 v[16:19], v2 offset:36864
    v_mfma_f32_16x16x32_bf16 v[200:203], v[32:35], a[136:139], v[200:203]
    ds_read_b128 v[20:23], v2 offset:37888
    v_mfma_f32_16x16x32_bf16 v[196:199], v[36:39], a[72:75], v[196:199]
    ds_read_b128 v[24:27], v2 offset:43008
    v_mfma_f32_16x16x32_bf16 v[204:207], v[36:39], a[136:139], v[204:207]
    ds_read_b128 v[28:31], v2 offset:44032
    v_mfma_f32_16x16x32_bf16 v[192:195], v[40:43], a[76:79], v[192:195]
    v_mfma_f32_16x16x32_bf16 v[200:203], v[40:43], a[140:143], v[200:203]
    v_mfma_f32_16x16x32_bf16 v[196:199], v[44:47], a[76:79], v[196:199]
    v_mfma_f32_16x16x32_bf16 v[204:207], v[44:47], a[140:143], v[204:207]
    s_waitcnt vmcnt(12)
    s_barrier
    s_waitcnt lgkmcnt(4)
    v_mfma_f32_16x16x32_bf16 v[192:195], v[64:67], a[80:83], v[192:195]
    ds_read_b128 v[32:35], v2 offset:49152
    v_mfma_f32_16x16x32_bf16 v[200:203], v[64:67], a[144:147], v[200:203]
    ds_read_b128 v[36:39], v2 offset:50176
    v_mfma_f32_16x16x32_bf16 v[196:199], v[68:71], a[80:83], v[196:199]
    ds_read_b128 v[40:43], v2 offset:55296
    v_mfma_f32_16x16x32_bf16 v[204:207], v[68:71], a[144:147], v[204:207]
    ds_read_b128 v[44:47], v2 offset:56320
    v_mfma_f32_16x16x32_bf16 v[192:195], v[72:75], a[84:87], v[192:195]
    v_mfma_f32_16x16x32_bf16 v[200:203], v[72:75], a[148:151], v[200:203]
    v_mfma_f32_16x16x32_bf16 v[196:199], v[76:79], a[84:87], v[196:199]
    v_mfma_f32_16x16x32_bf16 v[204:207], v[76:79], a[148:151], v[204:207]
    s_waitcnt lgkmcnt(4)
    v_mfma_f32_16x16x32_bf16 v[192:195], v[16:19], a[88:91], v[192:195]
    ds_read_b128 v[64:67], v2 offset:61440
    v_mfma_f32_16x16x32_bf16 v[200:203], v[16:19], a[152:155], v[200:203]
    ds_read_b128 v[68:71], v2 offset:62464
    v_mfma_f32_16x16x32_bf16 v[196:199], v[20:23], a[88:91], v[196:199]
    ds_read_b128 v[72:75], v10 offset:2048
    v_mfma_f32_16x16x32_bf16 v[204:207], v[20:23], a[152:155], v[204:207]
    ds_read_b128 v[76:79], v10 offset:3072
    v_mfma_f32_16x16x32_bf16 v[192:195], v[24:27], a[92:95], v[192:195]
    v_mfma_f32_16x16x32_bf16 v[200:203], v[24:27], a[156:159], v[200:203]
    v_mfma_f32_16x16x32_bf16 v[196:199], v[28:31], a[92:95], v[196:199]
    v_mfma_f32_16x16x32_bf16 v[204:207], v[28:31], a[156:159], v[204:207]
    s_waitcnt lgkmcnt(4)
    v_mfma_f32_16x16x32_bf16 v[192:195], v[32:35], a[96:99], v[192:195]
    ds_read_b128 v[16:19], v10 offset:8192
    v_mfma_f32_16x16x32_bf16 v[200:203], v[32:35], a[160:163], v[200:203]
    ds_read_b128 v[20:23], v10 offset:9216
    v_mfma_f32_16x16x32_bf16 v[196:199], v[36:39], a[96:99], v[196:199]
    ds_read_b128 v[24:27], v10 offset:14336
    v_mfma_f32_16x16x32_bf16 v[204:207], v[36:39], a[160:163], v[204:207]
    ds_read_b128 v[28:31], v10 offset:15360
    v_mfma_f32_16x16x32_bf16 v[192:195], v[40:43], a[100:103], v[192:195]
    s_add_u32 m0, s14, 53248
    s_add_u32 s58, s12, 73728
    buffer_load_dwordx4 v2, s[40:43], s58 offen offset:0 lds
    v_mfma_f32_16x16x32_bf16 v[200:203], v[40:43], a[164:167], v[200:203]
    s_add_u32 s58, s12, 89088
    buffer_load_dwordx4 v2, s[40:43], s58 offen offset:1024 lds
    v_mfma_f32_16x16x32_bf16 v[196:199], v[44:47], a[100:103], v[196:199]
    s_add_u32 m0, s14, 77824
    s_add_u32 s58, s12, 77824
    buffer_load_dwordx4 v2, s[40:43], s58 offen offset:0 lds
    v_mfma_f32_16x16x32_bf16 v[204:207], v[44:47], a[164:167], v[204:207]
    s_add_u32 s58, s12, 93184
    buffer_load_dwordx4 v2, s[40:43], s58 offen offset:1024 lds
    s_waitcnt lgkmcnt(4)
    v_mfma_f32_16x16x32_bf16 v[192:195], v[64:67], a[104:107], v[192:195]
    ds_read_b128 v[32:35], v10 offset:20480
    v_mfma_f32_16x16x32_bf16 v[200:203], v[64:67], a[168:171], v[200:203]
    ds_read_b128 v[36:39], v10 offset:21504
    v_mfma_f32_16x16x32_bf16 v[196:199], v[68:71], a[104:107], v[196:199]
    ds_read_b128 v[40:43], v10 offset:26624
    v_mfma_f32_16x16x32_bf16 v[204:207], v[68:71], a[168:171], v[204:207]
    ds_read_b128 v[44:47], v10 offset:27648
    v_mfma_f32_16x16x32_bf16 v[192:195], v[72:75], a[108:111], v[192:195]
    v_mfma_f32_16x16x32_bf16 v[200:203], v[72:75], a[172:175], v[200:203]
    v_mfma_f32_16x16x32_bf16 v[196:199], v[76:79], a[108:111], v[196:199]
    v_mfma_f32_16x16x32_bf16 v[204:207], v[76:79], a[172:175], v[204:207]
    s_waitcnt vmcnt(12)
    s_barrier
    s_waitcnt lgkmcnt(4)
    v_mfma_f32_16x16x32_bf16 v[192:195], v[16:19], a[112:115], v[192:195]
    ds_read_b128 v[64:67], v2 offset:2048
    v_mfma_f32_16x16x32_bf16 v[200:203], v[16:19], a[176:179], v[200:203]
    ds_read_b128 v[68:71], v2 offset:3072
    v_mfma_f32_16x16x32_bf16 v[196:199], v[20:23], a[112:115], v[196:199]
    ds_read_b128 v[72:75], v2 offset:8192
    v_mfma_f32_16x16x32_bf16 v[204:207], v[20:23], a[176:179], v[204:207]
    ds_read_b128 v[76:79], v2 offset:9216
    v_mfma_f32_16x16x32_bf16 v[192:195], v[24:27], a[116:119], v[192:195]
    v_mfma_f32_16x16x32_bf16 v[200:203], v[24:27], a[180:183], v[200:203]
    v_mfma_f32_16x16x32_bf16 v[196:199], v[28:31], a[116:119], v[196:199]
    v_mfma_f32_16x16x32_bf16 v[204:207], v[28:31], a[180:183], v[204:207]
    s_waitcnt lgkmcnt(4)
    v_mfma_f32_16x16x32_bf16 v[192:195], v[32:35], a[120:123], v[192:195]
    ds_read_b128 v[16:19], v2 offset:14336
    v_mfma_f32_16x16x32_bf16 v[200:203], v[32:35], a[184:187], v[200:203]
    ds_read_b128 v[20:23], v2 offset:15360
    v_mfma_f32_16x16x32_bf16 v[196:199], v[36:39], a[120:123], v[196:199]
    ds_read_b128 v[24:27], v2 offset:20480
    v_mfma_f32_16x16x32_bf16 v[204:207], v[36:39], a[184:187], v[204:207]
    ds_read_b128 v[28:31], v2 offset:21504
    v_mfma_f32_16x16x32_bf16 v[192:195], v[40:43], a[124:127], v[192:195]
    v_mfma_f32_16x16x32_bf16 v[200:203], v[40:43], a[188:191], v[200:203]
    v_mfma_f32_16x16x32_bf16 v[196:199], v[44:47], a[124:127], v[196:199]
    v_mfma_f32_16x16x32_bf16 v[204:207], v[44:47], a[188:191], v[204:207]
    s_waitcnt lgkmcnt(4)
    v_mfma_f32_16x16x32_bf16 v[208:211], v[64:67], a[64:67], 0
    ds_read_b128 v[32:35], v2 offset:26624
    v_mfma_f32_16x16x32_bf16 v[216:219], v[64:67], a[128:131], 0
    ds_read_b128 v[36:39], v2 offset:27648
    v_mfma_f32_16x16x32_bf16 v[212:215], v[68:71], a[64:67], 0
    ds_read_b128 v[40:43], v2 offset:32768
    v_mfma_f32_16x16x32_bf16 v[220:223], v[68:71], a[128:131], 0
    ds_read_b128 v[44:47], v2 offset:33792
    v_mfma_f32_16x16x32_bf16 v[208:211], v[72:75], a[68:71], v[208:211]
    v_cvt_pk_bf16_f32 v48, v192, v193
    v_cvt_pk_bf16_f32 v49, v194, v195
    v_cvt_pk_bf16_f32 v50, v196, v197
    v_cvt_pk_bf16_f32 v51, v198, v199
    ds_write_b128 v3, v[48:51] offset:0
    v_mfma_f32_16x16x32_bf16 v[216:219], v[72:75], a[132:135], v[216:219]
    v_cvt_pk_bf16_f32 v52, v200, v201
    v_cvt_pk_bf16_f32 v53, v202, v203
    v_cvt_pk_bf16_f32 v54, v204, v205
    v_cvt_pk_bf16_f32 v55, v206, v207
    ds_write_b128 v3, v[52:55] offset:1280
    v_mfma_f32_16x16x32_bf16 v[212:215], v[76:79], a[68:71], v[212:215]
    ds_read_b128 v[56:59], v4
    ds_read_b128 v[60:63], v4 offset:1280
    v_mfma_f32_16x16x32_bf16 v[220:223], v[76:79], a[132:135], v[220:223]
    s_waitcnt lgkmcnt(0)
    v_mfma_f32_16x16x32_bf16 v[208:211], v[16:19], a[72:75], v[208:211]
    ds_read_b128 v[64:67], v2 offset:38912
    v_mfma_f32_16x16x32_bf16 v[216:219], v[16:19], a[136:139], v[216:219]
    ds_read_b128 v[68:71], v2 offset:39936
    v_mfma_f32_16x16x32_bf16 v[212:215], v[20:23], a[72:75], v[212:215]
    ds_read_b128 v[72:75], v2 offset:45056
    v_mfma_f32_16x16x32_bf16 v[220:223], v[20:23], a[136:139], v[220:223]
    ds_read_b128 v[76:79], v2 offset:46080
    v_mfma_f32_16x16x32_bf16 v[208:211], v[24:27], a[76:79], v[208:211]
    v_mfma_f32_16x16x32_bf16 v[216:219], v[24:27], a[140:143], v[216:219]
    v_mfma_f32_16x16x32_bf16 v[212:215], v[28:31], a[76:79], v[212:215]
    v_mfma_f32_16x16x32_bf16 v[220:223], v[28:31], a[140:143], v[220:223]
    s_waitcnt vmcnt(8)
    s_barrier
    s_waitcnt lgkmcnt(0)
    v_mfma_f32_16x16x32_bf16 v[208:211], v[32:35], a[80:83], v[208:211]
    ds_read_b128 v[16:19], v2 offset:51200
    v_mfma_f32_16x16x32_bf16 v[216:219], v[32:35], a[144:147], v[216:219]
    ds_read_b128 v[20:23], v2 offset:52224
    v_mfma_f32_16x16x32_bf16 v[212:215], v[36:39], a[80:83], v[212:215]
    ds_read_b128 v[24:27], v2 offset:57344
    v_mfma_f32_16x16x32_bf16 v[220:223], v[36:39], a[144:147], v[220:223]
    ds_read_b128 v[28:31], v2 offset:58368
    v_mfma_f32_16x16x32_bf16 v[208:211], v[40:43], a[84:87], v[208:211]
    buffer_store_dwordx4 v[56:59], v5, s[44:47], s52 offen sc1
    v_mfma_f32_16x16x32_bf16 v[216:219], v[40:43], a[148:151], v[216:219]
    buffer_store_dwordx4 v[60:63], v6, s[44:47], s52 offen sc1
    v_mfma_f32_16x16x32_bf16 v[212:215], v[44:47], a[84:87], v[212:215]
    v_mfma_f32_16x16x32_bf16 v[220:223], v[44:47], a[148:151], v[220:223]
    s_waitcnt lgkmcnt(4)
    v_mfma_f32_16x16x32_bf16 v[208:211], v[64:67], a[88:91], v[208:211]
    ds_read_b128 v[32:35], v2 offset:63488
    v_mfma_f32_16x16x32_bf16 v[216:219], v[64:67], a[152:155], v[216:219]
    ds_read_b128 v[36:39], v2 offset:64512
    v_mfma_f32_16x16x32_bf16 v[212:215], v[68:71], a[88:91], v[212:215]
    ds_read_b128 v[40:43], v10 offset:4096
    v_mfma_f32_16x16x32_bf16 v[220:223], v[68:71], a[152:155], v[220:223]
    ds_read_b128 v[44:47], v10 offset:5120
    v_mfma_f32_16x16x32_bf16 v[208:211], v[72:75], a[92:95], v[208:211]
    v_mfma_f32_16x16x32_bf16 v[216:219], v[72:75], a[156:159], v[216:219]
    v_mfma_f32_16x16x32_bf16 v[212:215], v[76:79], a[92:95], v[212:215]
    v_mfma_f32_16x16x32_bf16 v[220:223], v[76:79], a[156:159], v[220:223]
    s_waitcnt lgkmcnt(4)
    v_mfma_f32_16x16x32_bf16 v[208:211], v[16:19], a[96:99], v[208:211]
    ds_read_b128 v[64:67], v10 offset:10240
    v_mfma_f32_16x16x32_bf16 v[216:219], v[16:19], a[160:163], v[216:219]
    ds_read_b128 v[68:71], v10 offset:11264
    v_mfma_f32_16x16x32_bf16 v[212:215], v[20:23], a[96:99], v[212:215]
    ds_read_b128 v[72:75], v10 offset:16384
    v_mfma_f32_16x16x32_bf16 v[220:223], v[20:23], a[160:163], v[220:223]
    ds_read_b128 v[76:79], v10 offset:17408
    v_mfma_f32_16x16x32_bf16 v[208:211], v[24:27], a[100:103], v[208:211]
    v_mfma_f32_16x16x32_bf16 v[216:219], v[24:27], a[164:167], v[216:219]
    v_mfma_f32_16x16x32_bf16 v[212:215], v[28:31], a[100:103], v[212:215]
    v_mfma_f32_16x16x32_bf16 v[220:223], v[28:31], a[164:167], v[220:223]
    s_waitcnt lgkmcnt(4)
    v_mfma_f32_16x16x32_bf16 v[208:211], v[32:35], a[104:107], v[208:211]
    ds_read_b128 v[16:19], v10 offset:22528
    v_mfma_f32_16x16x32_bf16 v[216:219], v[32:35], a[168:171], v[216:219]
    ds_read_b128 v[20:23], v10 offset:23552
    v_mfma_f32_16x16x32_bf16 v[212:215], v[36:39], a[104:107], v[212:215]
    ds_read_b128 v[24:27], v10 offset:28672
    v_mfma_f32_16x16x32_bf16 v[220:223], v[36:39], a[168:171], v[220:223]
    ds_read_b128 v[28:31], v10 offset:29696
    v_mfma_f32_16x16x32_bf16 v[208:211], v[40:43], a[108:111], v[208:211]
    v_mfma_f32_16x16x32_bf16 v[216:219], v[40:43], a[172:175], v[216:219]
    v_mfma_f32_16x16x32_bf16 v[212:215], v[44:47], a[108:111], v[212:215]
    v_mfma_f32_16x16x32_bf16 v[220:223], v[44:47], a[172:175], v[220:223]
    s_waitcnt vmcnt(6)
    s_barrier
    s_waitcnt lgkmcnt(4)
    v_mfma_f32_16x16x32_bf16 v[208:211], v[64:67], a[112:115], v[208:211]
    ds_read_b128 v[32:35], v2 offset:4096
    v_mfma_f32_16x16x32_bf16 v[216:219], v[64:67], a[176:179], v[216:219]
    ds_read_b128 v[36:39], v2 offset:5120
    v_mfma_f32_16x16x32_bf16 v[212:215], v[68:71], a[112:115], v[212:215]
    ds_read_b128 v[40:43], v2 offset:10240
    v_mfma_f32_16x16x32_bf16 v[220:223], v[68:71], a[176:179], v[220:223]
    ds_read_b128 v[44:47], v2 offset:11264
    v_mfma_f32_16x16x32_bf16 v[208:211], v[72:75], a[116:119], v[208:211]
    v_mfma_f32_16x16x32_bf16 v[216:219], v[72:75], a[180:183], v[216:219]
    v_mfma_f32_16x16x32_bf16 v[212:215], v[76:79], a[116:119], v[212:215]
    v_mfma_f32_16x16x32_bf16 v[220:223], v[76:79], a[180:183], v[220:223]
    s_waitcnt lgkmcnt(4)
    v_mfma_f32_16x16x32_bf16 v[208:211], v[16:19], a[120:123], v[208:211]
    ds_read_b128 v[64:67], v2 offset:16384
    v_mfma_f32_16x16x32_bf16 v[216:219], v[16:19], a[184:187], v[216:219]
    ds_read_b128 v[68:71], v2 offset:17408
    v_mfma_f32_16x16x32_bf16 v[212:215], v[20:23], a[120:123], v[212:215]
    ds_read_b128 v[72:75], v2 offset:22528
    v_mfma_f32_16x16x32_bf16 v[220:223], v[20:23], a[184:187], v[220:223]
    ds_read_b128 v[76:79], v2 offset:23552
    v_mfma_f32_16x16x32_bf16 v[208:211], v[24:27], a[124:127], v[208:211]
    v_mfma_f32_16x16x32_bf16 v[216:219], v[24:27], a[188:191], v[216:219]
    v_mfma_f32_16x16x32_bf16 v[212:215], v[28:31], a[124:127], v[212:215]
    v_mfma_f32_16x16x32_bf16 v[220:223], v[28:31], a[188:191], v[220:223]
    s_waitcnt lgkmcnt(4)
    v_mfma_f32_16x16x32_bf16 v[224:227], v[32:35], a[64:67], 0
    ds_read_b128 v[16:19], v2 offset:28672
    v_mfma_f32_16x16x32_bf16 v[232:235], v[32:35], a[128:131], 0
    ds_read_b128 v[20:23], v2 offset:29696
    v_mfma_f32_16x16x32_bf16 v[228:231], v[36:39], a[64:67], 0
    ds_read_b128 v[24:27], v2 offset:34816
    v_mfma_f32_16x16x32_bf16 v[236:239], v[36:39], a[128:131], 0
    ds_read_b128 v[28:31], v2 offset:35840
    v_mfma_f32_16x16x32_bf16 v[224:227], v[40:43], a[68:71], v[224:227]
    v_cvt_pk_bf16_f32 v48, v208, v209
    v_cvt_pk_bf16_f32 v49, v210, v211
    v_cvt_pk_bf16_f32 v50, v212, v213
    v_cvt_pk_bf16_f32 v51, v214, v215
    ds_write_b128 v3, v[48:51] offset:0
    v_mfma_f32_16x16x32_bf16 v[232:235], v[40:43], a[132:135], v[232:235]
    v_cvt_pk_bf16_f32 v52, v216, v217
    v_cvt_pk_bf16_f32 v53, v218, v219
    v_cvt_pk_bf16_f32 v54, v220, v221
    v_cvt_pk_bf16_f32 v55, v222, v223
    ds_write_b128 v3, v[52:55] offset:1280
    v_mfma_f32_16x16x32_bf16 v[228:231], v[44:47], a[68:71], v[228:231]
    ds_read_b128 v[56:59], v4
    ds_read_b128 v[60:63], v4 offset:1280
    v_mfma_f32_16x16x32_bf16 v[236:239], v[44:47], a[132:135], v[236:239]
    s_waitcnt lgkmcnt(0)
    v_mfma_f32_16x16x32_bf16 v[224:227], v[64:67], a[72:75], v[224:227]
    ds_read_b128 v[32:35], v2 offset:40960
    v_mfma_f32_16x16x32_bf16 v[232:235], v[64:67], a[136:139], v[232:235]
    ds_read_b128 v[36:39], v2 offset:41984
    v_mfma_f32_16x16x32_bf16 v[228:231], v[68:71], a[72:75], v[228:231]
    ds_read_b128 v[40:43], v2 offset:47104
    v_mfma_f32_16x16x32_bf16 v[236:239], v[68:71], a[136:139], v[236:239]
    ds_read_b128 v[44:47], v2 offset:48128
    v_mfma_f32_16x16x32_bf16 v[224:227], v[72:75], a[76:79], v[224:227]
    v_mfma_f32_16x16x32_bf16 v[232:235], v[72:75], a[140:143], v[232:235]
    v_mfma_f32_16x16x32_bf16 v[228:231], v[76:79], a[76:79], v[228:231]
    v_mfma_f32_16x16x32_bf16 v[236:239], v[76:79], a[140:143], v[236:239]
    s_waitcnt vmcnt(2)
    s_barrier
    s_waitcnt lgkmcnt(0)
    v_mfma_f32_16x16x32_bf16 v[224:227], v[16:19], a[80:83], v[224:227]
    ds_read_b128 v[64:67], v2 offset:53248
    v_mfma_f32_16x16x32_bf16 v[232:235], v[16:19], a[144:147], v[232:235]
    ds_read_b128 v[68:71], v2 offset:54272
    v_mfma_f32_16x16x32_bf16 v[228:231], v[20:23], a[80:83], v[228:231]
    ds_read_b128 v[72:75], v2 offset:59392
    v_mfma_f32_16x16x32_bf16 v[236:239], v[20:23], a[144:147], v[236:239]
    ds_read_b128 v[76:79], v2 offset:60416
    v_mfma_f32_16x16x32_bf16 v[224:227], v[24:27], a[84:87], v[224:227]
    buffer_store_dwordx4 v[56:59], v5, s[44:47], s53 offen sc1
    v_mfma_f32_16x16x32_bf16 v[232:235], v[24:27], a[148:151], v[232:235]
    buffer_store_dwordx4 v[60:63], v6, s[44:47], s53 offen sc1
    v_mfma_f32_16x16x32_bf16 v[228:231], v[28:31], a[84:87], v[228:231]
    v_mfma_f32_16x16x32_bf16 v[236:239], v[28:31], a[148:151], v[236:239]
    s_waitcnt lgkmcnt(4)
    v_mfma_f32_16x16x32_bf16 v[224:227], v[32:35], a[88:91], v[224:227]
    ds_read_b128 v[16:19], v10 offset:0
    v_mfma_f32_16x16x32_bf16 v[232:235], v[32:35], a[152:155], v[232:235]
    ds_read_b128 v[20:23], v10 offset:1024
    v_mfma_f32_16x16x32_bf16 v[228:231], v[36:39], a[88:91], v[228:231]
    ds_read_b128 v[24:27], v10 offset:6144
    v_mfma_f32_16x16x32_bf16 v[236:239], v[36:39], a[152:155], v[236:239]
    ds_read_b128 v[28:31], v10 offset:7168
    v_mfma_f32_16x16x32_bf16 v[224:227], v[40:43], a[92:95], v[224:227]
    v_mfma_f32_16x16x32_bf16 v[232:235], v[40:43], a[156:159], v[232:235]
    v_mfma_f32_16x16x32_bf16 v[228:231], v[44:47], a[92:95], v[228:231]
    v_mfma_f32_16x16x32_bf16 v[236:239], v[44:47], a[156:159], v[236:239]
    s_waitcnt lgkmcnt(4)
    v_mfma_f32_16x16x32_bf16 v[224:227], v[64:67], a[96:99], v[224:227]
    ds_read_b128 v[32:35], v10 offset:12288
    v_mfma_f32_16x16x32_bf16 v[232:235], v[64:67], a[160:163], v[232:235]
    ds_read_b128 v[36:39], v10 offset:13312
    v_mfma_f32_16x16x32_bf16 v[228:231], v[68:71], a[96:99], v[228:231]
    ds_read_b128 v[40:43], v10 offset:18432
    v_mfma_f32_16x16x32_bf16 v[236:239], v[68:71], a[160:163], v[236:239]
    ds_read_b128 v[44:47], v10 offset:19456
    v_mfma_f32_16x16x32_bf16 v[224:227], v[72:75], a[100:103], v[224:227]
    v_mfma_f32_16x16x32_bf16 v[232:235], v[72:75], a[164:167], v[232:235]
    v_mfma_f32_16x16x32_bf16 v[228:231], v[76:79], a[100:103], v[228:231]
    v_mfma_f32_16x16x32_bf16 v[236:239], v[76:79], a[164:167], v[236:239]
    s_waitcnt lgkmcnt(4)
    v_mfma_f32_16x16x32_bf16 v[224:227], v[16:19], a[104:107], v[224:227]
    ds_read_b128 v[64:67], v10 offset:24576
    v_mfma_f32_16x16x32_bf16 v[232:235], v[16:19], a[168:171], v[232:235]
    ds_read_b128 v[68:71], v10 offset:25600
    v_mfma_f32_16x16x32_bf16 v[228:231], v[20:23], a[104:107], v[228:231]
    ds_read_b128 v[72:75], v10 offset:30720
    v_mfma_f32_16x16x32_bf16 v[236:239], v[20:23], a[168:171], v[236:239]
    ds_read_b128 v[76:79], v10 offset:31744
    v_mfma_f32_16x16x32_bf16 v[224:227], v[24:27], a[108:111], v[224:227]
    v_mfma_f32_16x16x32_bf16 v[232:235], v[24:27], a[172:175], v[232:235]
    v_mfma_f32_16x16x32_bf16 v[228:231], v[28:31], a[108:111], v[228:231]
    v_mfma_f32_16x16x32_bf16 v[236:239], v[28:31], a[172:175], v[236:239]
    s_waitcnt lgkmcnt(4)
    v_mfma_f32_16x16x32_bf16 v[224:227], v[32:35], a[112:115], v[224:227]
    v_mfma_f32_16x16x32_bf16 v[232:235], v[32:35], a[176:179], v[232:235]
    v_mfma_f32_16x16x32_bf16 v[228:231], v[36:39], a[112:115], v[228:231]
    v_mfma_f32_16x16x32_bf16 v[236:239], v[36:39], a[176:179], v[236:239]
    v_mfma_f32_16x16x32_bf16 v[224:227], v[40:43], a[116:119], v[224:227]
    v_mfma_f32_16x16x32_bf16 v[232:235], v[40:43], a[180:183], v[232:235]
    v_mfma_f32_16x16x32_bf16 v[228:231], v[44:47], a[116:119], v[228:231]
    v_mfma_f32_16x16x32_bf16 v[236:239], v[44:47], a[180:183], v[236:239]
    s_waitcnt lgkmcnt(0)
    v_mfma_f32_16x16x32_bf16 v[224:227], v[64:67], a[120:123], v[224:227]
    v_mfma_f32_16x16x32_bf16 v[232:235], v[64:67], a[184:187], v[232:235]
    v_mfma_f32_16x16x32_bf16 v[228:231], v[68:71], a[120:123], v[228:231]
    v_mfma_f32_16x16x32_bf16 v[236:239], v[68:71], a[184:187], v[236:239]
    v_mfma_f32_16x16x32_bf16 v[224:227], v[72:75], a[124:127], v[224:227]
    v_mfma_f32_16x16x32_bf16 v[232:235], v[72:75], a[188:191], v[232:235]
    v_mfma_f32_16x16x32_bf16 v[228:231], v[76:79], a[124:127], v[228:231]
    v_mfma_f32_16x16x32_bf16 v[236:239], v[76:79], a[188:191], v[236:239]
    s_nop 7
    v_cvt_pk_bf16_f32 v48, v224, v225
    v_cvt_pk_bf16_f32 v49, v226, v227
    v_cvt_pk_bf16_f32 v50, v228, v229
    v_cvt_pk_bf16_f32 v51, v230, v231
    ds_write_b128 v3, v[48:51] offset:0
    v_cvt_pk_bf16_f32 v52, v232, v233
    v_cvt_pk_bf16_f32 v53, v234, v235
    v_cvt_pk_bf16_f32 v54, v236, v237
    v_cvt_pk_bf16_f32 v55, v238, v239
    ds_write_b128 v3, v[52:55] offset:1280
    ds_read_b128 v[56:59], v4
    ds_read_b128 v[60:63], v4 offset:1280
    s_waitcnt lgkmcnt(0)
    buffer_store_dwordx4 v[56:59], v5, s[44:47], s54 offen sc1
    buffer_store_dwordx4 v[60:63], v6, s[44:47], s54 offen sc1
PH2_exit:
K_done:
    s_endpgm
.section .rodata,"a"
.p2align 6
.amdhsa_kernel standalone__weight_only_int_quip__prompt_kernel
  .amdhsa_next_free_vgpr 448
  .amdhsa_next_free_sgpr 102
  .amdhsa_accum_offset 256
  .amdhsa_group_segment_fixed_size 0
  .amdhsa_kernarg_size 72
  .amdhsa_user_sgpr_count 2
  .amdhsa_user_sgpr_kernarg_segment_ptr 1
  .amdhsa_system_sgpr_workgroup_id_x 1
  .amdhsa_float_denorm_mode_32 3
  .amdhsa_float_denorm_mode_16_64 3
.end_amdhsa_kernel
```
